```python
import torch

def _softmax(x, axis=-1):
    return torch.softmax(x, dim=axis)
def _gelu(x):
    return torch.nn.functional.gelu(x, approximate="tanh")
def _silu(x):
    return torch.nn.functional.silu(x)
def _sigmoid(x):
    return torch.sigmoid(x)
def _layernorm(x, axis=-1, eps=1e-5):
    m = x.mean(dim=axis, keepdim=True)
    v = x.var(dim=axis, keepdim=True, unbiased=False)
    return (x - m) / torch.sqrt(v + eps)
def _scatter_add(tgt, idx, src, axis=0):
    return tgt.clone().index_add_(axis, idx, src)
def _segment_sum(src, seg, n):
    out = torch.zeros((n,) + src.shape[1:], dtype=src.dtype)
    return out.index_add_(0, seg, src)
def _pad(x, pw):
    flat = tuple(v for pair in reversed(pw) for v in pair)
    return torch.nn.functional.pad(x, flat)

kernel_name = 'standalone__weight_only_int_omniquant__prompt'

def setup_inputs():

    _w = (lambda a: (lambda t: t.to(torch.bfloat16) if t.is_floating_point() else t)(torch.as_tensor(a)))
    B, S, D, F = 1, 2048, 576, 4608
    bits = 8
    G = 64 if 64 > 0 else D
    D = (D // G) * G
    ng = D // G
    qmax = (1 << bits) - 1
    qw = torch.randint(0, qmax + 1, (D, F)).to(torch.int32)
    scales = (torch.abs((lambda *s: torch.randn(*s, dtype=torch.bfloat16) * 0.05)(ng, F)) * 0.05 + 0.01).to(float)
    zeros = torch.randint(0, qmax + 1, (ng, F)).to(float)
    act_scale = (torch.abs((lambda *s: torch.randn(*s, dtype=torch.bfloat16) * 0.05)(D)) * 0.5 + 0.5).to(float)
    return {
        "x": _w((lambda *s: torch.randn(*s, dtype=torch.bfloat16) * 0.05)(B, S, D)),
        "qw": _w(qw),
        "scales": _w(scales),
        "zeros": _w(zeros),
        "act_scale": _w(act_scale),
    }

def reference(x, qw, scales, zeros, act_scale):
    B, S, D = x.shape
    ng, F = scales.shape
    G = D // ng
    s = (lambda x, n, axis: torch.repeat_interleave(x, n, dim=axis))(scales, G, axis=0)
    z = (lambda x, n, axis: torch.repeat_interleave(x, n, dim=axis))(zeros, G, axis=0)
    w = ((lambda x, dt: x.to(dt))(qw, x.dtype) - z) * s
    xs = x * (lambda x, dt: x.to(dt))(act_scale, x.dtype)
    return torch.einsum("bsd,df->bsf", xs, w)
```

```asm
; @launch grid=(256,1,1) block=(256,1,1) lds=163840
.amdgcn_target "amdgcn-amd-amdhsa--gfx950"
.text
.p2align 12
.fill 832, 4, 0xbf800000
.globl standalone__weight_only_int_omniquant__prompt_kernel
.p2align 8
.type standalone__weight_only_int_omniquant__prompt_kernel,@function
standalone__weight_only_int_omniquant__prompt_kernel:
    s_load_dwordx8 s[4:11], s[0:1], 0
    s_load_dwordx4 s[12:15], s[0:1], 32
    s_getpc_b64 s[78:79]
L_pfref:
    s_bfe_u32 s74, s2, 196611
    v_lshrrev_b32 v254, 6, v0
    v_lshl_add_u32 v254, s74, 2, v254
    v_and_b32 v253, 7, v0
    v_lshl_add_u32 v254, v254, 3, v253
    v_lshlrev_b32 v254, 7, v254
    v_min_u32 v254, L_done-L_pfref, v254
    global_load_dword v254, v254, s[78:79]
    s_and_b32 s74, s2, 7
    s_lshr_b32 s75, s2, 3
    s_and_b32 s76, s2, 1
    s_add_u32 s77, s75, s76
    s_cmp_ge_u32 s77, 32
    s_cbranch_scc1 L_done
    s_lshr_b32 s74, s74, 1
    s_mul_i32 s74, s74, 63
    s_lshl_b32 s76, s76, 5
    s_add_u32 s74, s74, s76
    s_add_u32 s74, s74, s75
    s_mul_i32 s69, s74, 9363
    s_lshr_b32 s69, s69, 16
    s_mul_i32 s75, s69, 7
    s_sub_u32 s74, s74, s75
    s_mov_b32 s70, s74
    v_lshrrev_b32 v255, 6, v0
    v_and_b32 v253, 15, v0
    v_readfirstlane_b32 s78, v255
    v_bfe_u32 v216, v0, 4, 2
    s_add_u32 s73, s74, s69
    s_mul_i32 s79, s73, 21846
    s_lshr_b32 s79, s79, 16
    s_mul_i32 s79, s79, 3
    s_sub_u32 s73, s73, s79
    s_mul_i32 s72, s73, 3
    s_and_b32 s67, s78, 1
    s_lshr_b32 s68, s78, 1
    s_lshl_b32 s48, s72, 7
    s_lshl_b32 s74, s69, 7
    s_lshl_b32 s75, s67, 6
    s_add_u32 s75, s75, s74
    s_mul_i32 s76, s68, 589824
    s_lshl_b32 s77, s75, 2
    s_add_u32 s76, s76, s77
    v_mul_u32_u24 v11, 147456, v216
    v_lshl_add_u32 v11, v253, 4, v11
    v_add_u32 v11, s76, v11
    s_mul_i32 s80, s72, 9216
    s_lshl_b32 s76, s80, 7
    v_add_u32 v1, s76, v11
    s_lshl_b32 s77, s75, 1
    v_lshlrev_b32 v218, 3, v253
    v_add_u32 v218, s77, v218
    s_lshl_b32 s76, s68, 6
    v_lshlrev_b32 v219, 4, v216
    v_add_u32 v219, s76, v219
    s_movk_i32 s41, 0x4800
    s_lshl_b32 s42, s41, 1
    s_add_u32 s43, s42, s41
    s_lshl_b32 s44, s41, 2
    s_add_u32 s45, s44, s41
    s_lshl_b32 s46, s43, 1
    s_add_u32 s47, s46, s41
    s_mov_b32 s22, 10616832
    s_mov_b32 s23, 0x20000
    s_mov_b32 s26, 82944
    s_mov_b32 s27, s23
    s_mov_b64 s[30:31], s[26:27]
    s_movk_i32 s34, 1152
    s_mov_b32 s35, s23
    s_waitcnt lgkmcnt(0)
    s_mov_b64 s[24:25], s[8:9]
    s_mov_b64 s[28:29], s[10:11]
    s_mov_b64 s[32:33], s[12:13]
    s_mov_b64 s[20:21], s[6:7]
    buffer_load_dwordx4 v[16:19], v1, s[20:23], 0 offen
    buffer_load_dwordx4 v[20:23], v1, s[20:23], s41 offen
    buffer_load_dwordx2 v[136:137], v218, s[24:27], s80 offen
    buffer_load_dwordx2 v[138:139], v218, s[28:31], s80 offen
    buffer_load_dwordx4 v[140:143], v219, s[32:35], s48 offen
    buffer_load_dwordx4 v[24:27], v1, s[20:23], s42 offen
    buffer_load_dwordx4 v[28:31], v1, s[20:23], s43 offen
    buffer_load_dwordx4 v[32:35], v1, s[20:23], s44 offen
    buffer_load_dwordx4 v[36:39], v1, s[20:23], s45 offen
    buffer_load_dwordx4 v[40:43], v1, s[20:23], s46 offen
    buffer_load_dwordx4 v[44:47], v1, s[20:23], s47 offen
    s_add_u32 s76, s72, 1
    v_lshrrev_b32 v222, 5, v0
    v_add_u32 v222, s76, v222
    v_subrev_u32 v223, 9, v222
    v_min_u32 v222, v222, v223
    v_and_b32 v223, 31, v0
    v_mul_u32_u24 v220, 9216, v222
    v_lshl_add_u32 v220, v223, 3, v220
    s_lshl_b32 s76, s74, 1
    v_add_u32 v220, s76, v220
    v_lshlrev_b32 v221, 7, v222
    v_lshl_add_u32 v221, v223, 2, v221
    buffer_load_dwordx2 v[144:145], v220, s[24:27], 0 offen
    buffer_load_dwordx2 v[146:147], v220, s[28:31], 0 offen
    buffer_load_dword v148, v221, s[32:35], 0 offen
    s_mov_b32 s77, s70
    s_mul_i32 s70, s77, 288
    s_lshr_b32 s66, 9, s77
    s_and_b32 s66, s66, 1
    s_add_u32 s75, s77, 2
    s_mul_i32 s75, s75, 11
    s_lshr_b32 s75, s75, 5
    s_lshl_b32 s75, s75, 4
    s_add_u32 s70, s70, s75
    v_and_b32 v217, 63, v0
    s_mov_b64 s[16:17], s[4:5]
    s_mov_b32 s18, 2359296
    s_mov_b32 s19, 0x20000
    v_lshrrev_b32 v222, 3, v217
    s_lshl_b32 s76, s67, 3
    v_add_u32 v222, s76, v222
    v_lshrrev_b32 v223, 1, v222
    v_xor_b32 v223, v223, v217
    v_and_b32 v223, 7, v223
    v_mul_u32_u24 v252, 1152, v222
    v_lshl_add_u32 v2, v223, 4, v252
    s_mul_i32 s76, s68, 64
    s_add_u32 s76, s76, s70
    s_mul_i32 s77, s76, 1152
    s_mul_i32 s71, s76, 9216
    v_add_u32 v248, s77, v2
    v_add_u32 v249, 18432, v248
    v_add_u32 v250, 36864, v248
    v_add_u32 v251, 55296, v248
    s_movk_i32 s40, 0x800
    s_lshl_b32 s76, s67, 10
    s_mul_i32 s64, s68, 8192
    s_add_u32 s64, s64, s76
    s_mul_i32 s65, s68, 18432
    s_add_u32 s65, s65, s76
    s_add_u32 s49, s48, 128
    s_cmp_eq_u32 s49, 1152
    s_cselect_b32 s49, 0, s49
    s_add_u32 s50, s49, 128
    s_cmp_eq_u32 s50, 1152
    s_cselect_b32 s50, 0, s50
    s_add_u32 s51, s50, 128
    s_cmp_eq_u32 s51, 1152
    s_cselect_b32 s51, 0, s51
    s_add_u32 s52, s51, 128
    s_cmp_eq_u32 s52, 1152
    s_cselect_b32 s52, 0, s52
    s_add_u32 s53, s52, 128
    s_cmp_eq_u32 s53, 1152
    s_cselect_b32 s53, 0, s53
    s_add_u32 s54, s53, 128
    s_cmp_eq_u32 s54, 1152
    s_cselect_b32 s54, 0, s54
    s_add_u32 s55, s54, 128
    s_cmp_eq_u32 s55, 1152
    s_cselect_b32 s55, 0, s55
    s_add_u32 s56, s55, 128
    s_cmp_eq_u32 s56, 1152
    s_cselect_b32 s56, 0, s56
    s_add_u32 m0, s64, 65536
    s_mov_b64 s[36:37], s[14:15]
    buffer_load_dwordx4 v248, s[16:19], s48 offen  lds
    s_add_u32 m0, m0, s40
    s_mov_b32 s38, 18874368
    buffer_load_dwordx4 v249, s[16:19], s48 offen  lds
    s_add_u32 m0, m0, s40
    s_mov_b32 s39, 0x20000
    buffer_load_dwordx4 v250, s[16:19], s48 offen  lds
    s_add_u32 m0, m0, s40
    v_and_b32 v223, 7, v217
    buffer_load_dwordx4 v251, s[16:19], s48 offen  lds
    v_min_u32 v223, 4, v223
    v_lshl_add_u32 v252, v223, 8, v252
    v_lshrrev_b32 v223, 2, v223
    v_xor_b32 v223, 1, v223
    v_mul_u32_u24 v223, 124, v223
    v_add_u32 v252, v252, v223
    v_lshrrev_b32 v222, 1, v253
    v_xor_b32 v222, v222, v216
    v_lshlrev_b32 v222, 4, v222
    v_lshl_add_u32 v3, v253, 7, v222
    s_mul_i32 s76, s68, 8192
    v_add_u32 v3, s76, v3
    v_xor_b32 v4, 64, v3
    v_add_u32 v5, 0x10000, v3
    v_add_u32 v6, 0x10000, v4
    s_lshl_b32 s76, s67, 12
    s_add_u32 s76, s76, 131072
    v_lshlrev_b32 v8, 4, v217
    v_add_u32 v8, s76, v8
    s_lshl_b32 s76, s68, 13
    v_add_u32 v7, s76, v8
    s_lshl_b32 s76, s67, 8
    s_add_u32 s76, s76, 36864
    v_lshlrev_b32 v9, 4, v253
    v_add_u32 v9, s76, v9
    s_lshl_b32 s76, s68, 7
    s_add_u32 s76, s76, 45056
    v_lshlrev_b32 v10, 5, v216
    v_add_u32 v10, s76, v10
    v_mul_u32_u24 v12, 36864, v216
    v_add_u32 v12, v12, v218
    v_add_u32 v13, 9216, v12
    v_add_u32 v14, 18432, v12
    v_add_u32 v15, 27648, v12
    s_mov_b32 s74, 5
    s_lshl_b32 s75, s69, 1
    s_mul_i32 s76, s69, 21846
    s_lshr_b32 s76, s76, 16
    s_mul_i32 s76, s76, 3
    s_sub_u32 s75, s69, s76
    s_mul_i32 s75, s75, 2
    s_lshl_b32 s76, s68, 4
    s_add_u32 s76, s76, s70
    s_add_u32 s76, s76, 128
    s_mul_i32 s76, s76, 1152
    s_mul_i32 s4, s75, 36864
    s_add_u32 s4, s4, s76
    s_add_u32 s75, s75, 1
    s_cmp_eq_u32 s75, s74
    s_cselect_b32 s75, 0, s75
    s_mul_i32 s5, s75, 36864
    s_add_u32 s5, s5, s76
    s_add_u32 s75, s75, 1
    s_cmp_eq_u32 s75, s74
    s_cselect_b32 s75, 0, s75
    s_mul_i32 s6, s75, 36864
    s_add_u32 s6, s6, s76
    s_add_u32 s75, s75, 1
    s_cmp_eq_u32 s75, s74
    s_cselect_b32 s75, 0, s75
    s_mul_i32 s7, s75, 36864
    s_add_u32 s7, s7, s76
    s_add_u32 s75, s75, 1
    s_cmp_eq_u32 s75, s74
    s_cselect_b32 s75, 0, s75
    s_mul_i32 s8, s75, 36864
    s_add_u32 s8, s8, s76
    s_add_u32 s75, s75, 1
    s_cmp_eq_u32 s75, s74
    s_cselect_b32 s75, 0, s75
    s_mul_i32 s9, s75, 36864
    s_add_u32 s9, s9, s76
    s_add_u32 s9, s70, 288
    s_mul_i32 s9, s9, 1152
    s_cmp_eq_u32 s66, 0
    s_cselect_b32 s9, 2359296, s9
    v_lshrrev_b32 v222, 5, v0
    v_and_b32 v223, 31, v0
    v_lshlrev_b32 v222, 10, v222
    v_lshl_add_u32 v222, v223, 4, v222
    v_add_u32 v222, 36864, v222
    v_lshlrev_b32 v223, 3, v0
    v_add_u32 v223, 45056, v223
    s_waitcnt vmcnt(13)
    v_lshlrev_b32 v112, 16, v136
    v_and_b32 v113, 0xffff0000, v136
    v_lshlrev_b32 v116, 16, v138
    v_and_b32 v117, 0xffff0000, v138
    v_lshlrev_b32 v114, 16, v137
    v_and_b32 v115, 0xffff0000, v137
    v_lshlrev_b32 v118, 16, v139
    v_and_b32 v119, 0xffff0000, v139
    v_mul_f32 v116, v116, v112
    v_mul_f32 v117, v117, v113
    v_mul_f32 v118, v118, v114
    v_mul_f32 v119, v119, v115
    v_mul_f32 v116, 0xbf800000, v116
    v_mul_f32 v117, 0xbf800000, v117
    v_mul_f32 v118, 0xbf800000, v118
    v_mul_f32 v119, 0xbf800000, v119
    v_lshlrev_b32 v128, 16, v140
    v_and_b32 v129, 0xffff0000, v140
    v_lshlrev_b32 v130, 16, v141
    v_and_b32 v131, 0xffff0000, v141
    v_lshlrev_b32 v132, 16, v142
    v_and_b32 v133, 0xffff0000, v142
    v_lshlrev_b32 v134, 16, v143
    v_and_b32 v135, 0xffff0000, v143
    s_waitcnt vmcnt(11)
    .p2align 3
    v_cvt_f32_i32 v16, v16
    v_cvt_f32_i32 v17, v17
    v_cvt_f32_i32 v18, v18
    v_cvt_f32_i32 v19, v19
    v_cvt_f32_i32 v20, v20
    v_cvt_f32_i32 v21, v21
    v_cvt_f32_i32 v22, v22
    v_cvt_f32_i32 v23, v23
    v_pk_fma_f32 v[16:17], v[16:17], v[112:113], v[116:117]
    v_pk_fma_f32 v[18:19], v[18:19], v[114:115], v[118:119]
    v_cvt_f32_i32 v24, v24
    v_cvt_f32_i32 v25, v25
    v_cvt_f32_i32 v26, v26
    v_cvt_f32_i32 v27, v27
    v_pk_fma_f32 v[20:21], v[20:21], v[112:113], v[116:117]
    v_pk_fma_f32 v[22:23], v[22:23], v[114:115], v[118:119]
    v_pk_mul_f32 v[16:17], v[16:17], v[128:129] op_sel:[0,0] op_sel_hi:[1,0]
    v_pk_mul_f32 v[18:19], v[18:19], v[128:129] op_sel:[0,0] op_sel_hi:[1,0]
    v_cvt_f32_i32 v28, v28
    v_cvt_f32_i32 v29, v29
    v_cvt_f32_i32 v30, v30
    v_cvt_f32_i32 v31, v31
    v_pk_fma_f32 v[24:25], v[24:25], v[112:113], v[116:117]
    v_pk_fma_f32 v[26:27], v[26:27], v[114:115], v[118:119]
    v_pk_mul_f32 v[20:21], v[20:21], v[128:129] op_sel:[0,1] op_sel_hi:[1,1]
    v_pk_mul_f32 v[22:23], v[22:23], v[128:129] op_sel:[0,1] op_sel_hi:[1,1]
    v_pk_fma_f32 v[28:29], v[28:29], v[112:113], v[116:117]
    v_pk_fma_f32 v[30:31], v[30:31], v[114:115], v[118:119]
    v_pk_mul_f32 v[24:25], v[24:25], v[130:131] op_sel:[0,0] op_sel_hi:[1,0]
    v_pk_mul_f32 v[26:27], v[26:27], v[130:131] op_sel:[0,0] op_sel_hi:[1,0]
    v_pk_mul_f32 v[28:29], v[28:29], v[130:131] op_sel:[0,1] op_sel_hi:[1,1]
    v_pk_mul_f32 v[30:31], v[30:31], v[130:131] op_sel:[0,1] op_sel_hi:[1,1]
    s_nop 1
    s_mul_i32 s81, s49, 9216
    v_add_u32 v1, s81, v11
    buffer_load_dwordx4 v[48:51], v1, s[20:23], 0 offen
    v_cvt_pk_bf16_f32 v168, v16, v20
    v_cvt_pk_bf16_f32 v172, v17, v21
    v_cvt_pk_bf16_f32 v176, v18, v22
    v_cvt_pk_bf16_f32 v180, v19, v23
    v_cvt_pk_bf16_f32 v169, v24, v28
    v_cvt_pk_bf16_f32 v173, v25, v29
    v_cvt_pk_bf16_f32 v177, v26, v30
    buffer_load_dwordx4 v[52:55], v1, s[20:23], s41 offen
    v_cvt_pk_bf16_f32 v181, v27, v31
    s_waitcnt vmcnt(9)
    .p2align 3
    v_cvt_f32_i32 v32, v32
    v_cvt_f32_i32 v33, v33
    v_cvt_f32_i32 v34, v34
    v_cvt_f32_i32 v35, v35
    v_cvt_f32_i32 v36, v36
    v_cvt_f32_i32 v37, v37
    v_cvt_f32_i32 v38, v38
    v_cvt_f32_i32 v39, v39
    v_pk_fma_f32 v[32:33], v[32:33], v[112:113], v[116:117]
    v_pk_fma_f32 v[34:35], v[34:35], v[114:115], v[118:119]
    v_cvt_f32_i32 v40, v40
    v_cvt_f32_i32 v41, v41
    v_cvt_f32_i32 v42, v42
    v_cvt_f32_i32 v43, v43
    v_pk_fma_f32 v[36:37], v[36:37], v[112:113], v[116:117]
    v_pk_fma_f32 v[38:39], v[38:39], v[114:115], v[118:119]
    v_pk_mul_f32 v[32:33], v[32:33], v[132:133] op_sel:[0,0] op_sel_hi:[1,0]
    v_pk_mul_f32 v[34:35], v[34:35], v[132:133] op_sel:[0,0] op_sel_hi:[1,0]
    v_cvt_f32_i32 v44, v44
    v_cvt_f32_i32 v45, v45
    v_cvt_f32_i32 v46, v46
    v_cvt_f32_i32 v47, v47
    v_pk_fma_f32 v[40:41], v[40:41], v[112:113], v[116:117]
    v_pk_fma_f32 v[42:43], v[42:43], v[114:115], v[118:119]
    v_pk_mul_f32 v[36:37], v[36:37], v[132:133] op_sel:[0,1] op_sel_hi:[1,1]
    v_pk_mul_f32 v[38:39], v[38:39], v[132:133] op_sel:[0,1] op_sel_hi:[1,1]
    v_pk_fma_f32 v[44:45], v[44:45], v[112:113], v[116:117]
    v_pk_fma_f32 v[46:47], v[46:47], v[114:115], v[118:119]
    v_pk_mul_f32 v[40:41], v[40:41], v[134:135] op_sel:[0,0] op_sel_hi:[1,0]
    v_pk_mul_f32 v[42:43], v[42:43], v[134:135] op_sel:[0,0] op_sel_hi:[1,0]
    v_pk_mul_f32 v[44:45], v[44:45], v[134:135] op_sel:[0,1] op_sel_hi:[1,1]
    v_pk_mul_f32 v[46:47], v[46:47], v[134:135] op_sel:[0,1] op_sel_hi:[1,1]
    s_nop 1
    buffer_load_dwordx4 v[56:59], v1, s[20:23], s42 offen
    v_cvt_pk_bf16_f32 v170, v32, v36
    v_cvt_pk_bf16_f32 v171, v40, v44
    v_cvt_pk_bf16_f32 v174, v33, v37
    v_cvt_pk_bf16_f32 v175, v41, v45
    v_cvt_pk_bf16_f32 v178, v34, v38
    v_cvt_pk_bf16_f32 v179, v42, v46
    v_cvt_pk_bf16_f32 v182, v35, v39
    buffer_load_dwordx4 v[60:63], v1, s[20:23], s43 offen
    v_cvt_pk_bf16_f32 v183, v43, v47
    ds_write_b128 v7, v[168:171] offset:0
    ds_write_b128 v7, v[172:175] offset:1024
    ds_write_b128 v7, v[176:179] offset:2048
    buffer_load_dwordx4 v[64:67], v1, s[20:23], s44 offen
    ds_write_b128 v7, v[180:183] offset:3072
    s_waitcnt vmcnt(9)
    v_lshlrev_b32 v152, 16, v144
    v_and_b32 v153, 0xffff0000, v144
    v_lshlrev_b32 v156, 16, v146
    v_and_b32 v157, 0xffff0000, v146
    buffer_load_dwordx4 v[68:71], v1, s[20:23], s45 offen
    v_lshlrev_b32 v154, 16, v145
    v_and_b32 v155, 0xffff0000, v145
    v_lshlrev_b32 v158, 16, v147
    v_and_b32 v159, 0xffff0000, v147
    v_mul_f32 v156, v156, v152
    v_mul_f32 v157, v157, v153
    v_mul_f32 v158, v158, v154
    buffer_load_dwordx4 v[72:75], v1, s[20:23], s46 offen
    v_mul_f32 v159, v159, v155
    v_mul_f32 v156, 0xbf800000, v156
    v_mul_f32 v157, 0xbf800000, v157
    v_mul_f32 v158, 0xbf800000, v158
    v_mul_f32 v159, 0xbf800000, v159
    v_lshlrev_b32 v160, 16, v148
    v_and_b32 v161, 0xffff0000, v148
    buffer_load_dwordx4 v[76:79], v1, s[20:23], s47 offen
    ds_write_b128 v222, v[152:155]
    ds_write_b128 v222, v[156:159] offset:512
    ds_write_b64 v223, v[160:161]
    s_add_u32 m0, s64, 81920
    s_nop 0
    buffer_load_dwordx4 v248, s[16:19], s49 offen  lds
    s_waitcnt vmcnt(9) lgkmcnt(0)
    s_barrier
    s_add_u32 m0, m0, s40
    ds_read_b128 v[120:123], v9 offset:0
    buffer_load_dwordx4 v249, s[16:19], s49 offen  lds
    s_call_b64 s[78:79], L_pad_B1
    ds_read_b128 v[124:127], v9 offset:512
    ds_read_b128 v[128:131], v10 offset:0
    ds_read_b128 v[132:135], v10 offset:16
    ds_read_b128 a[0:3], v8 offset:0
    s_add_u32 m0, m0, s40
    ds_read_b128 a[16:19], v8 offset:8192
    buffer_load_dwordx4 v250, s[16:19], s49 offen  lds
    ds_read_b128 v[216:219], v5 offset:0
    ds_read_b128 v[220:223], v6 offset:0
    ds_read_b128 a[4:7], v8 offset:1024
    ds_read_b128 a[20:23], v8 offset:9216
    ds_read_b128 a[8:11], v8 offset:2048
    s_add_u32 m0, m0, s40
    ds_read_b128 a[24:27], v8 offset:10240
    buffer_load_dwordx4 v251, s[16:19], s49 offen  lds
    ds_read_b128 a[12:15], v8 offset:3072
    ds_read_b128 a[28:31], v8 offset:11264
    s_mul_i32 s81, s50, 9216
    v_add_u32 v1, s81, v11
    buffer_load_dwordx4 v[80:83], v1, s[20:23], 0 offen
    ds_read_b128 v[224:227], v5 offset:2048
    s_waitcnt lgkmcnt(11)
    ds_read_b128 v[228:231], v6 offset:2048
    buffer_load_dwordx4 v[84:87], v1, s[20:23], s41 offen
    s_waitcnt vmcnt(10)
    .p2align 3
    v_cvt_f32_i32 v48, v48
    v_cvt_f32_i32 v49, v49
    v_cvt_f32_i32 v50, v50
    v_cvt_f32_i32 v51, v51
    v_cvt_f32_i32 v52, v52
    v_cvt_f32_i32 v53, v53
    v_cvt_f32_i32 v54, v54
    v_cvt_f32_i32 v55, v55
    v_pk_fma_f32 v[48:49], v[48:49], v[120:121], v[124:125]
    v_pk_fma_f32 v[50:51], v[50:51], v[122:123], v[126:127]
    v_cvt_f32_i32 v56, v56
    v_cvt_f32_i32 v57, v57
    v_cvt_f32_i32 v58, v58
    v_cvt_f32_i32 v59, v59
    v_pk_fma_f32 v[52:53], v[52:53], v[120:121], v[124:125]
    v_pk_fma_f32 v[54:55], v[54:55], v[122:123], v[126:127]
    v_pk_mul_f32 v[48:49], v[48:49], v[128:129] op_sel:[0,0] op_sel_hi:[1,0]
    v_pk_mul_f32 v[50:51], v[50:51], v[128:129] op_sel:[0,0] op_sel_hi:[1,0]
    v_cvt_f32_i32 v60, v60
    v_cvt_f32_i32 v61, v61
    v_cvt_f32_i32 v62, v62
    v_cvt_f32_i32 v63, v63
    v_pk_fma_f32 v[56:57], v[56:57], v[120:121], v[124:125]
    v_pk_fma_f32 v[58:59], v[58:59], v[122:123], v[126:127]
    v_pk_mul_f32 v[52:53], v[52:53], v[128:129] op_sel:[0,1] op_sel_hi:[1,1]
    v_pk_mul_f32 v[54:55], v[54:55], v[128:129] op_sel:[0,1] op_sel_hi:[1,1]
    v_pk_fma_f32 v[60:61], v[60:61], v[120:121], v[124:125]
    v_pk_fma_f32 v[62:63], v[62:63], v[122:123], v[126:127]
    v_pk_mul_f32 v[56:57], v[56:57], v[130:131] op_sel:[0,0] op_sel_hi:[1,0]
    v_pk_mul_f32 v[58:59], v[58:59], v[130:131] op_sel:[0,0] op_sel_hi:[1,0]
    v_pk_mul_f32 v[60:61], v[60:61], v[130:131] op_sel:[0,1] op_sel_hi:[1,1]
    v_pk_mul_f32 v[62:63], v[62:63], v[130:131] op_sel:[0,1] op_sel_hi:[1,1]
    s_nop 1
    buffer_load_dwordx4 v[88:91], v1, s[20:23], s42 offen
    ds_read_b128 v[112:115], v9 offset:1024
    v_cvt_pk_bf16_f32 v136, v48, v52
    v_cvt_pk_bf16_f32 v140, v49, v53
    ds_read_b128 v[116:119], v9 offset:1536
    v_cvt_pk_bf16_f32 v144, v50, v54
    v_cvt_pk_bf16_f32 v148, v51, v55
    ds_read_b128 v[128:131], v10 offset:256
    buffer_load_dwordx4 v[92:95], v1, s[20:23], s43 offen
    v_cvt_pk_bf16_f32 v137, v56, v60
    s_waitcnt lgkmcnt(11)
    ds_read_b128 v[232:235], v5 offset:4096
    v_cvt_pk_bf16_f32 v141, v57, v61
    v_cvt_pk_bf16_f32 v145, v58, v62
    ds_read_b128 v[236:239], v6 offset:4096
    v_cvt_pk_bf16_f32 v149, v59, v63
    buffer_load_dwordx4 v[96:99], v1, s[20:23], s44 offen
    ds_read_b128 v[240:243], v5 offset:6144
    s_call_b64 s[78:79], L_pad_B4
    s_call_b64 s[78:79], L_pad_B7
    ds_read_b128 v[244:247], v6 offset:6144
    s_waitcnt vmcnt(9)
    .p2align 3
    v_cvt_f32_i32 v64, v64
    v_cvt_f32_i32 v65, v65
    v_cvt_f32_i32 v66, v66
    v_cvt_f32_i32 v67, v67
    v_cvt_f32_i32 v68, v68
    v_cvt_f32_i32 v69, v69
    v_cvt_f32_i32 v70, v70
    v_cvt_f32_i32 v71, v71
    v_pk_fma_f32 v[64:65], v[64:65], v[120:121], v[124:125]
    v_pk_fma_f32 v[66:67], v[66:67], v[122:123], v[126:127]
    v_cvt_f32_i32 v72, v72
    v_cvt_f32_i32 v73, v73
    v_cvt_f32_i32 v74, v74
    v_cvt_f32_i32 v75, v75
    v_pk_fma_f32 v[68:69], v[68:69], v[120:121], v[124:125]
    v_pk_fma_f32 v[70:71], v[70:71], v[122:123], v[126:127]
    v_pk_mul_f32 v[64:65], v[64:65], v[132:133] op_sel:[0,0] op_sel_hi:[1,0]
    v_pk_mul_f32 v[66:67], v[66:67], v[132:133] op_sel:[0,0] op_sel_hi:[1,0]
    v_cvt_f32_i32 v76, v76
    v_cvt_f32_i32 v77, v77
    v_cvt_f32_i32 v78, v78
    v_cvt_f32_i32 v79, v79
    v_pk_fma_f32 v[72:73], v[72:73], v[120:121], v[124:125]
    v_pk_fma_f32 v[74:75], v[74:75], v[122:123], v[126:127]
    v_pk_mul_f32 v[68:69], v[68:69], v[132:133] op_sel:[0,1] op_sel_hi:[1,1]
    v_pk_mul_f32 v[70:71], v[70:71], v[132:133] op_sel:[0,1] op_sel_hi:[1,1]
    v_pk_fma_f32 v[76:77], v[76:77], v[120:121], v[124:125]
    v_pk_fma_f32 v[78:79], v[78:79], v[122:123], v[126:127]
    v_pk_mul_f32 v[72:73], v[72:73], v[134:135] op_sel:[0,0] op_sel_hi:[1,0]
    v_pk_mul_f32 v[74:75], v[74:75], v[134:135] op_sel:[0,0] op_sel_hi:[1,0]
    v_pk_mul_f32 v[76:77], v[76:77], v[134:135] op_sel:[0,1] op_sel_hi:[1,1]
    v_pk_mul_f32 v[78:79], v[78:79], v[134:135] op_sel:[0,1] op_sel_hi:[1,1]
    s_nop 1
    s_waitcnt lgkmcnt(9)
    v_mfma_f32_16x16x32_bf16 v[152:155], v[216:219], a[0:3], 0
    buffer_load_dwordx4 v[100:103], v1, s[20:23], s45 offen
    ds_read_b128 v[132:135], v10 offset:272
    v_mfma_f32_16x16x32_bf16 v[152:155], v[220:223], a[16:19], v[152:155]
    v_cvt_pk_bf16_f32 v138, v64, v68
    v_cvt_pk_bf16_f32 v139, v72, v76
    v_mfma_f32_16x16x32_bf16 v[156:159], v[216:219], a[4:7], 0
    buffer_load_dwordx4 v[104:107], v1, s[20:23], s46 offen
    ds_write_b128 v7, v[136:139] offset:16384
    v_mfma_f32_16x16x32_bf16 v[156:159], v[220:223], a[20:23], v[156:159]
    v_cvt_pk_bf16_f32 v142, v65, v69
    v_cvt_pk_bf16_f32 v143, v73, v77
    v_mfma_f32_16x16x32_bf16 v[160:163], v[216:219], a[8:11], 0
    buffer_load_dwordx4 v[108:111], v1, s[20:23], s47 offen
    v_mfma_f32_16x16x32_bf16 v[160:163], v[220:223], a[24:27], v[160:163]
    v_cvt_pk_bf16_f32 v146, v66, v70
    v_cvt_pk_bf16_f32 v147, v74, v78
    v_mfma_f32_16x16x32_bf16 v[164:167], v[216:219], a[12:15], 0
    s_add_u32 m0, s64, 98304
    ds_write_b128 v7, v[140:143] offset:17408
    v_mfma_f32_16x16x32_bf16 v[164:167], v[220:223], a[28:31], v[164:167]
    buffer_load_dwordx4 v248, s[16:19], s50 offen  lds
    s_waitcnt lgkmcnt(10)
    v_mfma_f32_16x16x32_bf16 v[168:171], v[224:227], a[0:3], 0
    v_cvt_pk_bf16_f32 v150, v67, v71
    v_cvt_pk_bf16_f32 v151, v75, v79
    v_mfma_f32_16x16x32_bf16 v[168:171], v[228:231], a[16:19], v[168:171]
    s_add_u32 m0, m0, s40
    ds_write_b128 v7, v[144:147] offset:18432
    v_mfma_f32_16x16x32_bf16 v[172:175], v[224:227], a[4:7], 0
    buffer_load_dwordx4 v249, s[16:19], s50 offen  lds
    s_call_b64 s[78:79], L_pad_V2
    v_mfma_f32_16x16x32_bf16 v[172:175], v[228:231], a[20:23], v[172:175]
    s_call_b64 s[78:79], L_pad_mid1
    s_call_b64 s[78:79], L_pad_small
    v_mfma_f32_16x16x32_bf16 v[176:179], v[224:227], a[8:11], 0
    s_add_u32 m0, m0, s40
    ds_write_b128 v7, v[148:151] offset:19456
    v_mfma_f32_16x16x32_bf16 v[176:179], v[228:231], a[24:27], v[176:179]
    buffer_load_dwordx4 v250, s[16:19], s50 offen  lds
    v_mfma_f32_16x16x32_bf16 v[180:183], v[224:227], a[12:15], 0
    v_mfma_f32_16x16x32_bf16 v[180:183], v[228:231], a[28:31], v[180:183]
    s_add_u32 m0, m0, s40
    s_waitcnt vmcnt(7) lgkmcnt(9)
    .p2align 3
    v_cvt_f32_i32 v80, v80
    v_cvt_f32_i32 v81, v81
    v_cvt_f32_i32 v82, v82
    v_cvt_f32_i32 v83, v83
    v_cvt_f32_i32 v84, v84
    v_cvt_f32_i32 v85, v85
    v_cvt_f32_i32 v86, v86
    v_cvt_f32_i32 v87, v87
    v_pk_fma_f32 v[80:81], v[80:81], v[112:113], v[116:117]
    v_pk_fma_f32 v[82:83], v[82:83], v[114:115], v[118:119]
    v_cvt_f32_i32 v88, v88
    v_cvt_f32_i32 v89, v89
    v_cvt_f32_i32 v90, v90
    v_cvt_f32_i32 v91, v91
    v_pk_fma_f32 v[84:85], v[84:85], v[112:113], v[116:117]
    v_pk_fma_f32 v[86:87], v[86:87], v[114:115], v[118:119]
    v_pk_mul_f32 v[80:81], v[80:81], v[128:129] op_sel:[0,0] op_sel_hi:[1,0]
    v_pk_mul_f32 v[82:83], v[82:83], v[128:129] op_sel:[0,0] op_sel_hi:[1,0]
    v_cvt_f32_i32 v92, v92
    v_cvt_f32_i32 v93, v93
    v_cvt_f32_i32 v94, v94
    v_cvt_f32_i32 v95, v95
    v_pk_fma_f32 v[88:89], v[88:89], v[112:113], v[116:117]
    v_pk_fma_f32 v[90:91], v[90:91], v[114:115], v[118:119]
    v_pk_mul_f32 v[84:85], v[84:85], v[128:129] op_sel:[0,1] op_sel_hi:[1,1]
    v_pk_mul_f32 v[86:87], v[86:87], v[128:129] op_sel:[0,1] op_sel_hi:[1,1]
    v_pk_fma_f32 v[92:93], v[92:93], v[112:113], v[116:117]
    v_pk_fma_f32 v[94:95], v[94:95], v[114:115], v[118:119]
    v_pk_mul_f32 v[88:89], v[88:89], v[130:131] op_sel:[0,0] op_sel_hi:[1,0]
    v_pk_mul_f32 v[90:91], v[90:91], v[130:131] op_sel:[0,0] op_sel_hi:[1,0]
    v_pk_mul_f32 v[92:93], v[92:93], v[130:131] op_sel:[0,1] op_sel_hi:[1,1]
    v_pk_mul_f32 v[94:95], v[94:95], v[130:131] op_sel:[0,1] op_sel_hi:[1,1]
    s_nop 1
    s_waitcnt lgkmcnt(7)
    v_mfma_f32_16x16x32_bf16 v[184:187], v[232:235], a[0:3], 0
    buffer_load_dwordx4 v251, s[16:19], s50 offen  lds
    s_branch L_seg_B1
    .p2align 12
L_pad_B1:
    s_setpc_b64 s[78:79]
L_seg_B1:
    v_mfma_f32_16x16x32_bf16 v[184:187], v[236:239], a[16:19], v[184:187]
    s_waitcnt lgkmcnt(0)
    s_barrier
    v_mfma_f32_16x16x32_bf16 v[188:191], v[232:235], a[4:7], 0
    s_mul_i32 s81, s51, 9216
    v_add_u32 v1, s81, v11
    buffer_load_dwordx4 v[16:19], v1, s[20:23], 0 offen
    v_mfma_f32_16x16x32_bf16 v[188:191], v[236:239], a[20:23], v[188:191]
    ds_read_b128 v[120:123], v9 offset:2048
    ds_read_b128 v[124:127], v9 offset:2560
    v_mfma_f32_16x16x32_bf16 v[192:195], v[232:235], a[8:11], 0
    ds_read_b128 v[128:131], v10 offset:512
    buffer_load_dwordx4 v[20:23], v1, s[20:23], s41 offen
    v_mfma_f32_16x16x32_bf16 v[192:195], v[236:239], a[24:27], v[192:195]
    ds_read_b128 a[32:35], v8 offset:16384
    ds_read_b128 a[48:51], v8 offset:24576
    v_mfma_f32_16x16x32_bf16 v[196:199], v[232:235], a[12:15], 0
    ds_read_b128 v[216:219], v5 offset:16384
    buffer_load_dwordx4 v[24:27], v1, s[20:23], s42 offen
    v_mfma_f32_16x16x32_bf16 v[196:199], v[236:239], a[28:31], v[196:199]
    ds_read_b128 v[220:223], v6 offset:16384
    ds_read_b128 a[36:39], v8 offset:17408
    v_mfma_f32_16x16x32_bf16 v[200:203], v[240:243], a[0:3], 0
    ds_read_b128 a[52:55], v8 offset:25600
    buffer_load_dwordx4 v[28:31], v1, s[20:23], s43 offen
    v_mfma_f32_16x16x32_bf16 v[200:203], v[244:247], a[16:19], v[200:203]
    ds_read_b128 a[40:43], v8 offset:18432
    ds_read_b128 a[56:59], v8 offset:26624
    v_mfma_f32_16x16x32_bf16 v[204:207], v[240:243], a[4:7], 0
    ds_read_b128 a[44:47], v8 offset:19456
    buffer_load_dwordx4 v[32:35], v1, s[20:23], s44 offen
    v_mfma_f32_16x16x32_bf16 v[204:207], v[244:247], a[20:23], v[204:207]
    ds_read_b128 a[60:63], v8 offset:27648
    ds_read_b128 v[224:227], v5 offset:18432
    v_mfma_f32_16x16x32_bf16 v[208:211], v[240:243], a[8:11], 0
    v_cvt_pk_bf16_f32 v136, v80, v84
    v_cvt_pk_bf16_f32 v140, v81, v85
    v_mfma_f32_16x16x32_bf16 v[208:211], v[244:247], a[24:27], v[208:211]
    buffer_load_dwordx4 v[36:39], v1, s[20:23], s45 offen
    ds_read_b128 v[228:231], v6 offset:18432
    v_mfma_f32_16x16x32_bf16 v[212:215], v[240:243], a[12:15], 0
    s_waitcnt lgkmcnt(11)
    ds_read_b128 v[232:235], v5 offset:20480
    v_mfma_f32_16x16x32_bf16 v[212:215], v[244:247], a[28:31], v[212:215]
    buffer_load_dwordx4 v[40:43], v1, s[20:23], s46 offen
    ds_read_b128 v[236:239], v6 offset:20480
    v_cvt_pk_bf16_f32 v144, v82, v86
    v_cvt_pk_bf16_f32 v148, v83, v87
    v_cvt_pk_bf16_f32 v137, v88, v92
    v_cvt_pk_bf16_f32 v141, v89, v93
    v_cvt_pk_bf16_f32 v145, v90, v94
    v_cvt_pk_bf16_f32 v149, v91, v95
    buffer_load_dwordx4 v[44:47], v1, s[20:23], s47 offen
    s_waitcnt vmcnt(12)
    .p2align 3
    v_cvt_f32_i32 v96, v96
    v_cvt_f32_i32 v97, v97
    v_cvt_f32_i32 v98, v98
    v_cvt_f32_i32 v99, v99
    v_cvt_f32_i32 v100, v100
    v_cvt_f32_i32 v101, v101
    v_cvt_f32_i32 v102, v102
    v_cvt_f32_i32 v103, v103
    v_pk_fma_f32 v[96:97], v[96:97], v[112:113], v[116:117]
    v_pk_fma_f32 v[98:99], v[98:99], v[114:115], v[118:119]
    v_cvt_f32_i32 v104, v104
    v_cvt_f32_i32 v105, v105
    v_cvt_f32_i32 v106, v106
    v_cvt_f32_i32 v107, v107
    v_pk_fma_f32 v[100:101], v[100:101], v[112:113], v[116:117]
    v_pk_fma_f32 v[102:103], v[102:103], v[114:115], v[118:119]
    v_pk_mul_f32 v[96:97], v[96:97], v[132:133] op_sel:[0,0] op_sel_hi:[1,0]
    v_pk_mul_f32 v[98:99], v[98:99], v[132:133] op_sel:[0,0] op_sel_hi:[1,0]
    v_cvt_f32_i32 v108, v108
    v_cvt_f32_i32 v109, v109
    v_cvt_f32_i32 v110, v110
    v_cvt_f32_i32 v111, v111
    v_pk_fma_f32 v[104:105], v[104:105], v[112:113], v[116:117]
    v_pk_fma_f32 v[106:107], v[106:107], v[114:115], v[118:119]
    v_pk_mul_f32 v[100:101], v[100:101], v[132:133] op_sel:[0,1] op_sel_hi:[1,1]
    v_pk_mul_f32 v[102:103], v[102:103], v[132:133] op_sel:[0,1] op_sel_hi:[1,1]
    v_pk_fma_f32 v[108:109], v[108:109], v[112:113], v[116:117]
    v_pk_fma_f32 v[110:111], v[110:111], v[114:115], v[118:119]
    v_pk_mul_f32 v[104:105], v[104:105], v[134:135] op_sel:[0,0] op_sel_hi:[1,0]
    v_pk_mul_f32 v[106:107], v[106:107], v[134:135] op_sel:[0,0] op_sel_hi:[1,0]
    v_pk_mul_f32 v[108:109], v[108:109], v[134:135] op_sel:[0,1] op_sel_hi:[1,1]
    v_pk_mul_f32 v[110:111], v[110:111], v[134:135] op_sel:[0,1] op_sel_hi:[1,1]
    s_nop 1
    s_waitcnt lgkmcnt(4)
    v_mfma_f32_16x16x32_bf16 v[152:155], v[216:219], a[32:35], v[152:155]
    s_add_u32 m0, s64, 114688
    v_cvt_pk_bf16_f32 v138, v96, v100
    v_mfma_f32_16x16x32_bf16 v[152:155], v[220:223], a[48:51], v[152:155]
    buffer_load_dwordx4 v248, s[16:19], s51 offen  lds
    ds_read_b128 v[132:135], v10 offset:528
    v_mfma_f32_16x16x32_bf16 v[156:159], v[216:219], a[36:39], v[156:159]
    v_cvt_pk_bf16_f32 v139, v104, v108
    v_cvt_pk_bf16_f32 v142, v97, v101
    v_mfma_f32_16x16x32_bf16 v[156:159], v[220:223], a[52:55], v[156:159]
    s_add_u32 m0, m0, s40
    ds_write_b128 v7, v[136:139] offset:0
    v_mfma_f32_16x16x32_bf16 v[160:163], v[216:219], a[40:43], v[160:163]
    buffer_load_dwordx4 v249, s[16:19], s51 offen  lds
    ds_read_b128 v[240:243], v5 offset:22528
    v_mfma_f32_16x16x32_bf16 v[160:163], v[220:223], a[56:59], v[160:163]
    v_cvt_pk_bf16_f32 v143, v105, v109
    v_cvt_pk_bf16_f32 v146, v98, v102
    v_mfma_f32_16x16x32_bf16 v[164:167], v[216:219], a[44:47], v[164:167]
    s_add_u32 m0, m0, s40
    ds_write_b128 v7, v[140:143] offset:1024
    v_mfma_f32_16x16x32_bf16 v[164:167], v[220:223], a[60:63], v[164:167]
    buffer_load_dwordx4 v250, s[16:19], s51 offen  lds
    ds_read_b128 v[244:247], v6 offset:22528
    s_waitcnt lgkmcnt(7)
    v_mfma_f32_16x16x32_bf16 v[168:171], v[224:227], a[32:35], v[168:171]
    v_cvt_pk_bf16_f32 v147, v106, v110
    v_cvt_pk_bf16_f32 v150, v99, v103
    v_mfma_f32_16x16x32_bf16 v[168:171], v[228:231], a[48:51], v[168:171]
    s_add_u32 m0, m0, s40
    ds_write_b128 v7, v[144:147] offset:2048
    v_mfma_f32_16x16x32_bf16 v[172:175], v[224:227], a[36:39], v[172:175]
    buffer_load_dwordx4 v251, s[16:19], s51 offen  lds
    v_mfma_f32_16x16x32_bf16 v[172:175], v[228:231], a[52:55], v[172:175]
    v_cvt_pk_bf16_f32 v151, v107, v111
    v_mfma_f32_16x16x32_bf16 v[176:179], v[224:227], a[40:43], v[176:179]
    s_mul_i32 s81, s52, 9216
    v_add_u32 v1, s81, v11
    buffer_load_dwordx4 v[48:51], v1, s[20:23], 0 offen
    v_mfma_f32_16x16x32_bf16 v[176:179], v[228:231], a[56:59], v[176:179]
    ds_write_b128 v7, v[148:151] offset:3072
    v_mfma_f32_16x16x32_bf16 v[180:183], v[224:227], a[44:47], v[180:183]
    v_mfma_f32_16x16x32_bf16 v[180:183], v[228:231], a[60:63], v[180:183]
    s_waitcnt vmcnt(9)
    .p2align 3
    v_cvt_f32_i32 v16, v16
    v_cvt_f32_i32 v17, v17
    v_cvt_f32_i32 v18, v18
    v_cvt_f32_i32 v19, v19
    v_cvt_f32_i32 v20, v20
    v_cvt_f32_i32 v21, v21
    v_cvt_f32_i32 v22, v22
    v_cvt_f32_i32 v23, v23
    v_pk_fma_f32 v[16:17], v[16:17], v[120:121], v[124:125]
    v_pk_fma_f32 v[18:19], v[18:19], v[122:123], v[126:127]
    v_cvt_f32_i32 v24, v24
    v_cvt_f32_i32 v25, v25
    v_cvt_f32_i32 v26, v26
    v_cvt_f32_i32 v27, v27
    v_pk_fma_f32 v[20:21], v[20:21], v[120:121], v[124:125]
    v_pk_fma_f32 v[22:23], v[22:23], v[122:123], v[126:127]
    v_pk_mul_f32 v[16:17], v[16:17], v[128:129] op_sel:[0,0] op_sel_hi:[1,0]
    v_pk_mul_f32 v[18:19], v[18:19], v[128:129] op_sel:[0,0] op_sel_hi:[1,0]
    v_cvt_f32_i32 v28, v28
    v_cvt_f32_i32 v29, v29
    v_cvt_f32_i32 v30, v30
    v_cvt_f32_i32 v31, v31
    v_pk_fma_f32 v[24:25], v[24:25], v[120:121], v[124:125]
    v_pk_fma_f32 v[26:27], v[26:27], v[122:123], v[126:127]
    v_pk_mul_f32 v[20:21], v[20:21], v[128:129] op_sel:[0,1] op_sel_hi:[1,1]
    v_pk_mul_f32 v[22:23], v[22:23], v[128:129] op_sel:[0,1] op_sel_hi:[1,1]
    v_pk_fma_f32 v[28:29], v[28:29], v[120:121], v[124:125]
    v_pk_fma_f32 v[30:31], v[30:31], v[122:123], v[126:127]
    v_pk_mul_f32 v[24:25], v[24:25], v[130:131] op_sel:[0,0] op_sel_hi:[1,0]
    v_pk_mul_f32 v[26:27], v[26:27], v[130:131] op_sel:[0,0] op_sel_hi:[1,0]
    v_pk_mul_f32 v[28:29], v[28:29], v[130:131] op_sel:[0,1] op_sel_hi:[1,1]
    v_pk_mul_f32 v[30:31], v[30:31], v[130:131] op_sel:[0,1] op_sel_hi:[1,1]
    s_nop 1
    s_waitcnt lgkmcnt(7)
    v_mfma_f32_16x16x32_bf16 v[184:187], v[232:235], a[32:35], v[184:187]
    buffer_load_dwordx4 v[52:55], v1, s[20:23], s41 offen
    s_waitcnt lgkmcnt(0)
    s_barrier
    v_mfma_f32_16x16x32_bf16 v[184:187], v[236:239], a[48:51], v[184:187]
    ds_read_b128 v[112:115], v9 offset:3072
    ds_read_b128 v[116:119], v9 offset:3584
    v_mfma_f32_16x16x32_bf16 v[188:191], v[232:235], a[36:39], v[188:191]
    ds_read_b128 v[128:131], v10 offset:768
    ds_read_b128 a[64:67], v8 offset:0
    v_mfma_f32_16x16x32_bf16 v[188:191], v[236:239], a[52:55], v[188:191]
    buffer_load_dwordx4 v[56:59], v1, s[20:23], s42 offen
    ds_read_b128 a[80:83], v8 offset:8192
    v_mfma_f32_16x16x32_bf16 v[192:195], v[232:235], a[40:43], v[192:195]
    ds_read_b128 v[216:219], v5 offset:32768
    ds_read_b128 v[220:223], v6 offset:32768
    v_mfma_f32_16x16x32_bf16 v[192:195], v[236:239], a[56:59], v[192:195]
    ds_read_b128 a[68:71], v8 offset:1024
    ds_read_b128 a[84:87], v8 offset:9216
    v_mfma_f32_16x16x32_bf16 v[196:199], v[232:235], a[44:47], v[196:199]
    buffer_load_dwordx4 v[60:63], v1, s[20:23], s43 offen
    ds_read_b128 a[72:75], v8 offset:2048
    v_mfma_f32_16x16x32_bf16 v[196:199], v[236:239], a[60:63], v[196:199]
    ds_read_b128 a[88:91], v8 offset:10240
    ds_read_b128 a[76:79], v8 offset:3072
    v_mfma_f32_16x16x32_bf16 v[200:203], v[240:243], a[32:35], v[200:203]
    v_cvt_pk_bf16_f32 v136, v16, v20
    v_cvt_pk_bf16_f32 v140, v17, v21
    v_mfma_f32_16x16x32_bf16 v[200:203], v[244:247], a[48:51], v[200:203]
    buffer_load_dwordx4 v[64:67], v1, s[20:23], s44 offen
    ds_read_b128 a[92:95], v8 offset:11264
    v_mfma_f32_16x16x32_bf16 v[204:207], v[240:243], a[36:39], v[204:207]
    ds_read_b128 v[224:227], v5 offset:34816
    ds_read_b128 v[228:231], v6 offset:34816
    v_mfma_f32_16x16x32_bf16 v[204:207], v[244:247], a[52:55], v[204:207]
    v_cvt_pk_bf16_f32 v144, v18, v22
    v_cvt_pk_bf16_f32 v148, v19, v23
    v_mfma_f32_16x16x32_bf16 v[208:211], v[240:243], a[40:43], v[208:211]
    buffer_load_dwordx4 v[68:71], v1, s[20:23], s45 offen
    s_waitcnt lgkmcnt(11)
    ds_read_b128 v[232:235], v5 offset:36864
    v_mfma_f32_16x16x32_bf16 v[208:211], v[244:247], a[56:59], v[208:211]
    ds_read_b128 v[236:239], v6 offset:36864
    v_mfma_f32_16x16x32_bf16 v[212:215], v[240:243], a[44:47], v[212:215]
    v_cvt_pk_bf16_f32 v137, v24, v28
    v_cvt_pk_bf16_f32 v141, v25, v29
    v_mfma_f32_16x16x32_bf16 v[212:215], v[244:247], a[60:63], v[212:215]
    buffer_load_dwordx4 v[72:75], v1, s[20:23], s46 offen
    v_cvt_pk_bf16_f32 v145, v26, v30
    v_cvt_pk_bf16_f32 v149, v27, v31
    s_waitcnt vmcnt(11)
    .p2align 3
    v_cvt_f32_i32 v32, v32
    v_cvt_f32_i32 v33, v33
    v_cvt_f32_i32 v34, v34
    v_cvt_f32_i32 v35, v35
    v_cvt_f32_i32 v36, v36
    v_cvt_f32_i32 v37, v37
    v_cvt_f32_i32 v38, v38
    v_cvt_f32_i32 v39, v39
    v_pk_fma_f32 v[32:33], v[32:33], v[120:121], v[124:125]
    v_pk_fma_f32 v[34:35], v[34:35], v[122:123], v[126:127]
    v_cvt_f32_i32 v40, v40
    v_cvt_f32_i32 v41, v41
    v_cvt_f32_i32 v42, v42
    v_cvt_f32_i32 v43, v43
    v_pk_fma_f32 v[36:37], v[36:37], v[120:121], v[124:125]
    v_pk_fma_f32 v[38:39], v[38:39], v[122:123], v[126:127]
    v_pk_mul_f32 v[32:33], v[32:33], v[132:133] op_sel:[0,0] op_sel_hi:[1,0]
    v_pk_mul_f32 v[34:35], v[34:35], v[132:133] op_sel:[0,0] op_sel_hi:[1,0]
    v_cvt_f32_i32 v44, v44
    v_cvt_f32_i32 v45, v45
    v_cvt_f32_i32 v46, v46
    v_cvt_f32_i32 v47, v47
    v_pk_fma_f32 v[40:41], v[40:41], v[120:121], v[124:125]
    v_pk_fma_f32 v[42:43], v[42:43], v[122:123], v[126:127]
    v_pk_mul_f32 v[36:37], v[36:37], v[132:133] op_sel:[0,1] op_sel_hi:[1,1]
    v_pk_mul_f32 v[38:39], v[38:39], v[132:133] op_sel:[0,1] op_sel_hi:[1,1]
    v_pk_fma_f32 v[44:45], v[44:45], v[120:121], v[124:125]
    v_pk_fma_f32 v[46:47], v[46:47], v[122:123], v[126:127]
    v_pk_mul_f32 v[40:41], v[40:41], v[134:135] op_sel:[0,0] op_sel_hi:[1,0]
    v_pk_mul_f32 v[42:43], v[42:43], v[134:135] op_sel:[0,0] op_sel_hi:[1,0]
    v_pk_mul_f32 v[44:45], v[44:45], v[134:135] op_sel:[0,1] op_sel_hi:[1,1]
    v_pk_mul_f32 v[46:47], v[46:47], v[134:135] op_sel:[0,1] op_sel_hi:[1,1]
    s_nop 1
    s_waitcnt lgkmcnt(4)
    v_mfma_f32_16x16x32_bf16 v[152:155], v[216:219], a[64:67], v[152:155]
    buffer_load_dwordx4 v[76:79], v1, s[20:23], s47 offen
    ds_read_b128 v[132:135], v10 offset:784
    v_mfma_f32_16x16x32_bf16 v[152:155], v[220:223], a[80:83], v[152:155]
    v_cvt_pk_bf16_f32 v138, v32, v36
    v_cvt_pk_bf16_f32 v139, v40, v44
    v_mfma_f32_16x16x32_bf16 v[156:159], v[216:219], a[68:71], v[156:159]
    ds_write_b128 v7, v[136:139] offset:16384
    v_mfma_f32_16x16x32_bf16 v[156:159], v[220:223], a[84:87], v[156:159]
    s_mul_i32 s81, s53, 9216
    v_add_u32 v1, s81, v11
    buffer_load_dwordx4 v[80:83], v1, s[20:23], 0 offen
    v_mfma_f32_16x16x32_bf16 v[160:163], v[216:219], a[72:75], v[160:163]
    v_cvt_pk_bf16_f32 v142, v33, v37
    v_cvt_pk_bf16_f32 v143, v41, v45
    v_mfma_f32_16x16x32_bf16 v[160:163], v[220:223], a[88:91], v[160:163]
    ds_write_b128 v7, v[140:143] offset:17408
    v_mfma_f32_16x16x32_bf16 v[164:167], v[216:219], a[76:79], v[164:167]
    buffer_load_dwordx4 v[84:87], v1, s[20:23], s41 offen
    ds_read_b128 v[240:243], v5 offset:38912
    v_mfma_f32_16x16x32_bf16 v[164:167], v[220:223], a[92:95], v[164:167]
    v_cvt_pk_bf16_f32 v146, v34, v38
    v_cvt_pk_bf16_f32 v147, v42, v46
    s_waitcnt lgkmcnt(6)
    v_mfma_f32_16x16x32_bf16 v[168:171], v[224:227], a[64:67], v[168:171]
    ds_write_b128 v7, v[144:147] offset:18432
    v_mfma_f32_16x16x32_bf16 v[168:171], v[228:231], a[80:83], v[168:171]
    buffer_load_dwordx4 v[88:91], v1, s[20:23], s42 offen
    ds_read_b128 v[244:247], v6 offset:38912
    v_mfma_f32_16x16x32_bf16 v[172:175], v[224:227], a[68:71], v[172:175]
    v_cvt_pk_bf16_f32 v150, v35, v39
    v_cvt_pk_bf16_f32 v151, v43, v47
    v_mfma_f32_16x16x32_bf16 v[172:175], v[228:231], a[84:87], v[172:175]
    ds_write_b128 v7, v[148:151] offset:19456
    v_mfma_f32_16x16x32_bf16 v[176:179], v[224:227], a[72:75], v[176:179]
    buffer_load_dwordx4 v[92:95], v1, s[20:23], s43 offen
    v_mfma_f32_16x16x32_bf16 v[176:179], v[228:231], a[88:91], v[176:179]
    v_mfma_f32_16x16x32_bf16 v[180:183], v[224:227], a[76:79], v[180:183]
    v_mfma_f32_16x16x32_bf16 v[180:183], v[228:231], a[92:95], v[180:183]
    s_add_u32 m0, s64, 49152
    s_waitcnt vmcnt(8)
    .p2align 3
    v_cvt_f32_i32 v48, v48
    v_cvt_f32_i32 v49, v49
    v_cvt_f32_i32 v50, v50
    v_cvt_f32_i32 v51, v51
    v_cvt_f32_i32 v52, v52
    v_cvt_f32_i32 v53, v53
    v_cvt_f32_i32 v54, v54
    v_cvt_f32_i32 v55, v55
    v_pk_fma_f32 v[48:49], v[48:49], v[112:113], v[116:117]
    v_pk_fma_f32 v[50:51], v[50:51], v[114:115], v[118:119]
    v_cvt_f32_i32 v56, v56
    v_cvt_f32_i32 v57, v57
    v_cvt_f32_i32 v58, v58
    v_cvt_f32_i32 v59, v59
    v_pk_fma_f32 v[52:53], v[52:53], v[112:113], v[116:117]
    v_pk_fma_f32 v[54:55], v[54:55], v[114:115], v[118:119]
    v_pk_mul_f32 v[48:49], v[48:49], v[128:129] op_sel:[0,0] op_sel_hi:[1,0]
    v_pk_mul_f32 v[50:51], v[50:51], v[128:129] op_sel:[0,0] op_sel_hi:[1,0]
    v_cvt_f32_i32 v60, v60
    v_cvt_f32_i32 v61, v61
    v_cvt_f32_i32 v62, v62
    v_cvt_f32_i32 v63, v63
    v_pk_fma_f32 v[56:57], v[56:57], v[112:113], v[116:117]
    v_pk_fma_f32 v[58:59], v[58:59], v[114:115], v[118:119]
    v_pk_mul_f32 v[52:53], v[52:53], v[128:129] op_sel:[0,1] op_sel_hi:[1,1]
    v_pk_mul_f32 v[54:55], v[54:55], v[128:129] op_sel:[0,1] op_sel_hi:[1,1]
    v_pk_fma_f32 v[60:61], v[60:61], v[112:113], v[116:117]
    v_pk_fma_f32 v[62:63], v[62:63], v[114:115], v[118:119]
    v_pk_mul_f32 v[56:57], v[56:57], v[130:131] op_sel:[0,0] op_sel_hi:[1,0]
    v_pk_mul_f32 v[58:59], v[58:59], v[130:131] op_sel:[0,0] op_sel_hi:[1,0]
    v_pk_mul_f32 v[60:61], v[60:61], v[130:131] op_sel:[0,1] op_sel_hi:[1,1]
    v_pk_mul_f32 v[62:63], v[62:63], v[130:131] op_sel:[0,1] op_sel_hi:[1,1]
    s_nop 1
    s_waitcnt lgkmcnt(7)
    v_mfma_f32_16x16x32_bf16 v[184:187], v[232:235], a[64:67], v[184:187]
    buffer_load_dwordx4 v248, s[16:19], s52 offen  lds
    s_waitcnt lgkmcnt(0)
    s_barrier
    v_mfma_f32_16x16x32_bf16 v[184:187], v[236:239], a[80:83], v[184:187]
    ds_read_b128 v[120:123], v9 offset:4096
    ds_read_b128 v[124:127], v9 offset:4608
    v_mfma_f32_16x16x32_bf16 v[188:191], v[232:235], a[68:71], v[188:191]
    s_add_u32 m0, m0, s40
    ds_read_b128 v[128:131], v10 offset:1024
    v_mfma_f32_16x16x32_bf16 v[188:191], v[236:239], a[84:87], v[188:191]
    buffer_load_dwordx4 v249, s[16:19], s52 offen  lds
    ds_read_b128 a[96:99], v8 offset:16384
    v_mfma_f32_16x16x32_bf16 v[192:195], v[232:235], a[72:75], v[192:195]
    ds_read_b128 a[112:115], v8 offset:24576
    ds_read_b128 v[216:219], v5 offset:49152
    v_mfma_f32_16x16x32_bf16 v[192:195], v[236:239], a[88:91], v[192:195]
    ds_read_b128 v[220:223], v6 offset:49152
    s_add_u32 m0, m0, s40
    v_mfma_f32_16x16x32_bf16 v[196:199], v[232:235], a[76:79], v[196:199]
    buffer_load_dwordx4 v250, s[16:19], s52 offen  lds
    ds_read_b128 a[100:103], v8 offset:17408
    v_mfma_f32_16x16x32_bf16 v[196:199], v[236:239], a[92:95], v[196:199]
    ds_read_b128 a[116:119], v8 offset:25600
    ds_read_b128 a[104:107], v8 offset:18432
    v_mfma_f32_16x16x32_bf16 v[200:203], v[240:243], a[64:67], v[200:203]
    ds_read_b128 a[120:123], v8 offset:26624
    s_add_u32 m0, m0, s40
    v_mfma_f32_16x16x32_bf16 v[200:203], v[244:247], a[80:83], v[200:203]
    buffer_load_dwordx4 v251, s[16:19], s52 offen  lds
    ds_read_b128 a[108:111], v8 offset:19456
    v_mfma_f32_16x16x32_bf16 v[204:207], v[240:243], a[68:71], v[204:207]
    ds_read_b128 a[124:127], v8 offset:27648
    ds_read_b128 v[224:227], v5 offset:51200
    v_mfma_f32_16x16x32_bf16 v[204:207], v[244:247], a[84:87], v[204:207]
    ds_read_b128 v[228:231], v6 offset:51200
    s_waitcnt lgkmcnt(11)
    ds_read_b128 v[232:235], v5 offset:53248
    v_mfma_f32_16x16x32_bf16 v[208:211], v[240:243], a[72:75], v[208:211]
    buffer_load_dwordx4 v[96:99], v1, s[20:23], s44 offen
    ds_read_b128 v[236:239], v6 offset:53248
    v_mfma_f32_16x16x32_bf16 v[208:211], v[244:247], a[88:91], v[208:211]
    v_cvt_pk_bf16_f32 v136, v48, v52
    v_cvt_pk_bf16_f32 v140, v49, v53
    v_mfma_f32_16x16x32_bf16 v[212:215], v[240:243], a[76:79], v[212:215]
    v_cvt_pk_bf16_f32 v144, v50, v54
    v_cvt_pk_bf16_f32 v148, v51, v55
    v_mfma_f32_16x16x32_bf16 v[212:215], v[244:247], a[92:95], v[212:215]
    buffer_load_dwordx4 v[100:103], v1, s[20:23], s45 offen
    v_cvt_pk_bf16_f32 v137, v56, v60
    v_cvt_pk_bf16_f32 v141, v57, v61
    v_cvt_pk_bf16_f32 v145, v58, v62
    v_cvt_pk_bf16_f32 v149, v59, v63
    s_waitcnt vmcnt(10)
    .p2align 3
    v_cvt_f32_i32 v64, v64
    v_cvt_f32_i32 v65, v65
    v_cvt_f32_i32 v66, v66
    v_cvt_f32_i32 v67, v67
    v_cvt_f32_i32 v68, v68
    v_cvt_f32_i32 v69, v69
    v_cvt_f32_i32 v70, v70
    v_cvt_f32_i32 v71, v71
    v_pk_fma_f32 v[64:65], v[64:65], v[112:113], v[116:117]
    v_pk_fma_f32 v[66:67], v[66:67], v[114:115], v[118:119]
    v_cvt_f32_i32 v72, v72
    v_cvt_f32_i32 v73, v73
    v_cvt_f32_i32 v74, v74
    v_cvt_f32_i32 v75, v75
    v_pk_fma_f32 v[68:69], v[68:69], v[112:113], v[116:117]
    v_pk_fma_f32 v[70:71], v[70:71], v[114:115], v[118:119]
    v_pk_mul_f32 v[64:65], v[64:65], v[132:133] op_sel:[0,0] op_sel_hi:[1,0]
    v_pk_mul_f32 v[66:67], v[66:67], v[132:133] op_sel:[0,0] op_sel_hi:[1,0]
    v_cvt_f32_i32 v76, v76
    v_cvt_f32_i32 v77, v77
    v_cvt_f32_i32 v78, v78
    v_cvt_f32_i32 v79, v79
    v_pk_fma_f32 v[72:73], v[72:73], v[112:113], v[116:117]
    v_pk_fma_f32 v[74:75], v[74:75], v[114:115], v[118:119]
    v_pk_mul_f32 v[68:69], v[68:69], v[132:133] op_sel:[0,1] op_sel_hi:[1,1]
    v_pk_mul_f32 v[70:71], v[70:71], v[132:133] op_sel:[0,1] op_sel_hi:[1,1]
    v_pk_fma_f32 v[76:77], v[76:77], v[112:113], v[116:117]
    v_pk_fma_f32 v[78:79], v[78:79], v[114:115], v[118:119]
    v_pk_mul_f32 v[72:73], v[72:73], v[134:135] op_sel:[0,0] op_sel_hi:[1,0]
    v_pk_mul_f32 v[74:75], v[74:75], v[134:135] op_sel:[0,0] op_sel_hi:[1,0]
    v_pk_mul_f32 v[76:77], v[76:77], v[134:135] op_sel:[0,1] op_sel_hi:[1,1]
    v_pk_mul_f32 v[78:79], v[78:79], v[134:135] op_sel:[0,1] op_sel_hi:[1,1]
    s_nop 1
    s_waitcnt lgkmcnt(4)
    v_mfma_f32_16x16x32_bf16 v[152:155], v[216:219], a[96:99], v[152:155]
    buffer_load_dwordx4 v[104:107], v1, s[20:23], s46 offen
    ds_read_b128 v[132:135], v10 offset:1040
    v_mfma_f32_16x16x32_bf16 v[152:155], v[220:223], a[112:115], v[152:155]
    v_cvt_pk_bf16_f32 v138, v64, v68
    v_cvt_pk_bf16_f32 v139, v72, v76
    v_mfma_f32_16x16x32_bf16 v[156:159], v[216:219], a[100:103], v[156:159]
    ds_write_b128 v7, v[136:139] offset:0
    v_mfma_f32_16x16x32_bf16 v[156:159], v[220:223], a[116:119], v[156:159]
    buffer_load_dwordx4 v[108:111], v1, s[20:23], s47 offen
    ds_read_b128 v[240:243], v5 offset:55296
    v_mfma_f32_16x16x32_bf16 v[160:163], v[216:219], a[104:107], v[160:163]
    v_cvt_pk_bf16_f32 v142, v65, v69
    v_cvt_pk_bf16_f32 v143, v73, v77
    v_mfma_f32_16x16x32_bf16 v[160:163], v[220:223], a[120:123], v[160:163]
    v_cvt_pk_bf16_f32 v146, v66, v70
    v_cvt_pk_bf16_f32 v147, v74, v78
    v_mfma_f32_16x16x32_bf16 v[164:167], v[216:219], a[108:111], v[164:167]
    s_mul_i32 s81, s54, 9216
    v_add_u32 v1, s81, v11
    buffer_load_dwordx4 v[16:19], v1, s[20:23], 0 offen
    v_mfma_f32_16x16x32_bf16 v[164:167], v[220:223], a[124:127], v[164:167]
    ds_write_b128 v7, v[140:143] offset:1024
    s_waitcnt lgkmcnt(6)
    v_mfma_f32_16x16x32_bf16 v[168:171], v[224:227], a[96:99], v[168:171]
    v_cvt_pk_bf16_f32 v150, v67, v71
    v_cvt_pk_bf16_f32 v151, v75, v79
    v_mfma_f32_16x16x32_bf16 v[168:171], v[228:231], a[112:115], v[168:171]
    buffer_load_dwordx4 v[20:23], v1, s[20:23], s41 offen
    ds_read_b128 v[244:247], v6 offset:55296
    v_mfma_f32_16x16x32_bf16 v[172:175], v[224:227], a[100:103], v[172:175]
    ds_write_b128 v7, v[144:147] offset:2048
    v_mfma_f32_16x16x32_bf16 v[172:175], v[228:231], a[116:119], v[172:175]
    v_mfma_f32_16x16x32_bf16 v[176:179], v[224:227], a[104:107], v[176:179]
    buffer_load_dwordx4 v[24:27], v1, s[20:23], s42 offen
    v_mfma_f32_16x16x32_bf16 v[176:179], v[228:231], a[120:123], v[176:179]
    ds_write_b128 v7, v[148:151] offset:3072
    v_mfma_f32_16x16x32_bf16 v[180:183], v[224:227], a[108:111], v[180:183]
    v_mfma_f32_16x16x32_bf16 v[180:183], v[228:231], a[124:127], v[180:183]
    buffer_load_dwordx4 v[28:31], v1, s[20:23], s43 offen
    s_waitcnt vmcnt(12)
    .p2align 3
    v_cvt_f32_i32 v80, v80
    v_cvt_f32_i32 v81, v81
    v_cvt_f32_i32 v82, v82
    v_cvt_f32_i32 v83, v83
    v_cvt_f32_i32 v84, v84
    v_cvt_f32_i32 v85, v85
    v_cvt_f32_i32 v86, v86
    v_cvt_f32_i32 v87, v87
    v_pk_fma_f32 v[80:81], v[80:81], v[120:121], v[124:125]
    v_pk_fma_f32 v[82:83], v[82:83], v[122:123], v[126:127]
    v_cvt_f32_i32 v88, v88
    v_cvt_f32_i32 v89, v89
    v_cvt_f32_i32 v90, v90
    v_cvt_f32_i32 v91, v91
    v_pk_fma_f32 v[84:85], v[84:85], v[120:121], v[124:125]
    v_pk_fma_f32 v[86:87], v[86:87], v[122:123], v[126:127]
    v_pk_mul_f32 v[80:81], v[80:81], v[128:129] op_sel:[0,0] op_sel_hi:[1,0]
    v_pk_mul_f32 v[82:83], v[82:83], v[128:129] op_sel:[0,0] op_sel_hi:[1,0]
    v_cvt_f32_i32 v92, v92
    v_cvt_f32_i32 v93, v93
    v_cvt_f32_i32 v94, v94
    v_cvt_f32_i32 v95, v95
    v_pk_fma_f32 v[88:89], v[88:89], v[120:121], v[124:125]
    v_pk_fma_f32 v[90:91], v[90:91], v[122:123], v[126:127]
    v_pk_mul_f32 v[84:85], v[84:85], v[128:129] op_sel:[0,1] op_sel_hi:[1,1]
    v_pk_mul_f32 v[86:87], v[86:87], v[128:129] op_sel:[0,1] op_sel_hi:[1,1]
    v_pk_fma_f32 v[92:93], v[92:93], v[120:121], v[124:125]
    v_pk_fma_f32 v[94:95], v[94:95], v[122:123], v[126:127]
    v_pk_mul_f32 v[88:89], v[88:89], v[130:131] op_sel:[0,0] op_sel_hi:[1,0]
    v_pk_mul_f32 v[90:91], v[90:91], v[130:131] op_sel:[0,0] op_sel_hi:[1,0]
    v_pk_mul_f32 v[92:93], v[92:93], v[130:131] op_sel:[0,1] op_sel_hi:[1,1]
    v_pk_mul_f32 v[94:95], v[94:95], v[130:131] op_sel:[0,1] op_sel_hi:[1,1]
    s_nop 1
    s_waitcnt lgkmcnt(7)
    v_mfma_f32_16x16x32_bf16 v[184:187], v[232:235], a[96:99], v[184:187]
    s_add_u32 m0, s64, 65536
    s_branch L_seg_B4
    .p2align 12
L_pad_B4:
    s_setpc_b64 s[78:79]
L_seg_B4:
    v_mfma_f32_16x16x32_bf16 v[184:187], v[236:239], a[112:115], v[184:187]
    buffer_load_dwordx4 v248, s[16:19], s53 offen  lds
    s_waitcnt vmcnt(9) lgkmcnt(0)
    s_barrier
    v_mfma_f32_16x16x32_bf16 v[188:191], v[232:235], a[100:103], v[188:191]
    ds_read_b128 v[112:115], v9 offset:5120
    ds_read_b128 v[116:119], v9 offset:5632
    v_mfma_f32_16x16x32_bf16 v[188:191], v[236:239], a[116:119], v[188:191]
    s_add_u32 m0, m0, s40
    ds_read_b128 v[128:131], v10 offset:1280
    v_mfma_f32_16x16x32_bf16 v[192:195], v[232:235], a[104:107], v[192:195]
    buffer_load_dwordx4 v249, s[16:19], s53 offen  lds
    ds_read_b128 a[128:131], v8 offset:0
    v_mfma_f32_16x16x32_bf16 v[192:195], v[236:239], a[120:123], v[192:195]
    ds_read_b128 a[144:147], v8 offset:8192
    ds_read_b128 v[216:219], v3 offset:49152
    v_mfma_f32_16x16x32_bf16 v[196:199], v[232:235], a[108:111], v[196:199]
    ds_read_b128 v[220:223], v4 offset:49152
    s_add_u32 m0, m0, s40
    v_mfma_f32_16x16x32_bf16 v[196:199], v[236:239], a[124:127], v[196:199]
    buffer_load_dwordx4 v250, s[16:19], s53 offen  lds
    ds_read_b128 a[132:135], v8 offset:1024
    v_mfma_f32_16x16x32_bf16 v[200:203], v[240:243], a[96:99], v[200:203]
    ds_read_b128 a[148:151], v8 offset:9216
    ds_read_b128 a[136:139], v8 offset:2048
    v_mfma_f32_16x16x32_bf16 v[200:203], v[244:247], a[112:115], v[200:203]
    ds_read_b128 a[152:155], v8 offset:10240
    s_add_u32 m0, m0, s40
    v_mfma_f32_16x16x32_bf16 v[204:207], v[240:243], a[100:103], v[204:207]
    buffer_load_dwordx4 v251, s[16:19], s53 offen  lds
    ds_read_b128 a[140:143], v8 offset:3072
    v_mfma_f32_16x16x32_bf16 v[204:207], v[244:247], a[116:119], v[204:207]
    ds_read_b128 a[156:159], v8 offset:11264
    ds_read_b128 v[224:227], v3 offset:51200
    v_mfma_f32_16x16x32_bf16 v[208:211], v[240:243], a[104:107], v[208:211]
    ds_read_b128 v[228:231], v4 offset:51200
    s_waitcnt lgkmcnt(11)
    ds_read_b128 v[232:235], v3 offset:53248
    v_mfma_f32_16x16x32_bf16 v[208:211], v[244:247], a[120:123], v[208:211]
    buffer_load_dwordx4 v[32:35], v1, s[20:23], s44 offen
    ds_read_b128 v[236:239], v4 offset:53248
    v_mfma_f32_16x16x32_bf16 v[212:215], v[240:243], a[108:111], v[212:215]
    v_cvt_pk_bf16_f32 v136, v80, v84
    v_cvt_pk_bf16_f32 v140, v81, v85
    v_mfma_f32_16x16x32_bf16 v[212:215], v[244:247], a[124:127], v[212:215]
    v_cvt_pk_bf16_f32 v144, v82, v86
    v_cvt_pk_bf16_f32 v148, v83, v87
    v_cvt_pk_bf16_f32 v137, v88, v92
    buffer_load_dwordx4 v[36:39], v1, s[20:23], s45 offen
    v_cvt_pk_bf16_f32 v141, v89, v93
    v_cvt_pk_bf16_f32 v145, v90, v94
    v_cvt_pk_bf16_f32 v149, v91, v95
    s_waitcnt vmcnt(10)
    .p2align 3
    v_cvt_f32_i32 v96, v96
    v_cvt_f32_i32 v97, v97
    v_cvt_f32_i32 v98, v98
    v_cvt_f32_i32 v99, v99
    v_cvt_f32_i32 v100, v100
    v_cvt_f32_i32 v101, v101
    v_cvt_f32_i32 v102, v102
    v_cvt_f32_i32 v103, v103
    v_pk_fma_f32 v[96:97], v[96:97], v[120:121], v[124:125]
    v_pk_fma_f32 v[98:99], v[98:99], v[122:123], v[126:127]
    v_cvt_f32_i32 v104, v104
    v_cvt_f32_i32 v105, v105
    v_cvt_f32_i32 v106, v106
    v_cvt_f32_i32 v107, v107
    v_pk_fma_f32 v[100:101], v[100:101], v[120:121], v[124:125]
    v_pk_fma_f32 v[102:103], v[102:103], v[122:123], v[126:127]
    v_pk_mul_f32 v[96:97], v[96:97], v[132:133] op_sel:[0,0] op_sel_hi:[1,0]
    v_pk_mul_f32 v[98:99], v[98:99], v[132:133] op_sel:[0,0] op_sel_hi:[1,0]
    v_cvt_f32_i32 v108, v108
    v_cvt_f32_i32 v109, v109
    v_cvt_f32_i32 v110, v110
    v_cvt_f32_i32 v111, v111
    v_pk_fma_f32 v[104:105], v[104:105], v[120:121], v[124:125]
    v_pk_fma_f32 v[106:107], v[106:107], v[122:123], v[126:127]
    v_pk_mul_f32 v[100:101], v[100:101], v[132:133] op_sel:[0,1] op_sel_hi:[1,1]
    v_pk_mul_f32 v[102:103], v[102:103], v[132:133] op_sel:[0,1] op_sel_hi:[1,1]
    v_pk_fma_f32 v[108:109], v[108:109], v[120:121], v[124:125]
    v_pk_fma_f32 v[110:111], v[110:111], v[122:123], v[126:127]
    v_pk_mul_f32 v[104:105], v[104:105], v[134:135] op_sel:[0,0] op_sel_hi:[1,0]
    v_pk_mul_f32 v[106:107], v[106:107], v[134:135] op_sel:[0,0] op_sel_hi:[1,0]
    v_pk_mul_f32 v[108:109], v[108:109], v[134:135] op_sel:[0,1] op_sel_hi:[1,1]
    v_pk_mul_f32 v[110:111], v[110:111], v[134:135] op_sel:[0,1] op_sel_hi:[1,1]
    s_nop 1
    s_waitcnt lgkmcnt(4)
    v_mfma_f32_16x16x32_bf16 v[152:155], v[216:219], a[128:131], v[152:155]
    buffer_load_dwordx4 v[40:43], v1, s[20:23], s46 offen
    ds_read_b128 v[132:135], v10 offset:1296
    v_mfma_f32_16x16x32_bf16 v[152:155], v[220:223], a[144:147], v[152:155]
    v_cvt_pk_bf16_f32 v138, v96, v100
    v_cvt_pk_bf16_f32 v139, v104, v108
    v_mfma_f32_16x16x32_bf16 v[156:159], v[216:219], a[132:135], v[156:159]
    ds_write_b128 v7, v[136:139] offset:16384
    v_mfma_f32_16x16x32_bf16 v[156:159], v[220:223], a[148:151], v[156:159]
    buffer_load_dwordx4 v[44:47], v1, s[20:23], s47 offen
    ds_read_b128 v[240:243], v3 offset:55296
    v_mfma_f32_16x16x32_bf16 v[160:163], v[216:219], a[136:139], v[160:163]
    v_cvt_pk_bf16_f32 v142, v97, v101
    v_cvt_pk_bf16_f32 v143, v105, v109
    v_mfma_f32_16x16x32_bf16 v[160:163], v[220:223], a[152:155], v[160:163]
    v_cvt_pk_bf16_f32 v146, v98, v102
    v_cvt_pk_bf16_f32 v147, v106, v110
    v_mfma_f32_16x16x32_bf16 v[164:167], v[216:219], a[140:143], v[164:167]
    s_mul_i32 s81, s55, 9216
    v_add_u32 v1, s81, v11
    buffer_load_dwordx4 v[48:51], v1, s[20:23], 0 offen
    v_mfma_f32_16x16x32_bf16 v[164:167], v[220:223], a[156:159], v[164:167]
    ds_write_b128 v7, v[140:143] offset:17408
    s_waitcnt lgkmcnt(6)
    v_mfma_f32_16x16x32_bf16 v[168:171], v[224:227], a[128:131], v[168:171]
    v_cvt_pk_bf16_f32 v150, v99, v103
    v_cvt_pk_bf16_f32 v151, v107, v111
    v_mfma_f32_16x16x32_bf16 v[168:171], v[228:231], a[144:147], v[168:171]
    buffer_load_dwordx4 v[52:55], v1, s[20:23], s41 offen
    ds_read_b128 v[244:247], v4 offset:55296
    v_mfma_f32_16x16x32_bf16 v[172:175], v[224:227], a[132:135], v[172:175]
    ds_write_b128 v7, v[144:147] offset:18432
    v_mfma_f32_16x16x32_bf16 v[172:175], v[228:231], a[148:151], v[172:175]
    v_mfma_f32_16x16x32_bf16 v[176:179], v[224:227], a[136:139], v[176:179]
    buffer_load_dwordx4 v[56:59], v1, s[20:23], s42 offen
    v_mfma_f32_16x16x32_bf16 v[176:179], v[228:231], a[152:155], v[176:179]
    ds_write_b128 v7, v[148:151] offset:19456
    v_mfma_f32_16x16x32_bf16 v[180:183], v[224:227], a[140:143], v[180:183]
    v_mfma_f32_16x16x32_bf16 v[180:183], v[228:231], a[156:159], v[180:183]
    buffer_load_dwordx4 v[60:63], v1, s[20:23], s43 offen
    s_waitcnt vmcnt(12)
    .p2align 3
    v_cvt_f32_i32 v16, v16
    v_cvt_f32_i32 v17, v17
    v_cvt_f32_i32 v18, v18
    v_cvt_f32_i32 v19, v19
    v_cvt_f32_i32 v20, v20
    v_cvt_f32_i32 v21, v21
    v_cvt_f32_i32 v22, v22
    v_cvt_f32_i32 v23, v23
    v_pk_fma_f32 v[16:17], v[16:17], v[112:113], v[116:117]
    v_pk_fma_f32 v[18:19], v[18:19], v[114:115], v[118:119]
    v_cvt_f32_i32 v24, v24
    v_cvt_f32_i32 v25, v25
    v_cvt_f32_i32 v26, v26
    v_cvt_f32_i32 v27, v27
    v_pk_fma_f32 v[20:21], v[20:21], v[112:113], v[116:117]
    v_pk_fma_f32 v[22:23], v[22:23], v[114:115], v[118:119]
    v_pk_mul_f32 v[16:17], v[16:17], v[128:129] op_sel:[0,0] op_sel_hi:[1,0]
    v_pk_mul_f32 v[18:19], v[18:19], v[128:129] op_sel:[0,0] op_sel_hi:[1,0]
    v_cvt_f32_i32 v28, v28
    v_cvt_f32_i32 v29, v29
    v_cvt_f32_i32 v30, v30
    v_cvt_f32_i32 v31, v31
    v_pk_fma_f32 v[24:25], v[24:25], v[112:113], v[116:117]
    v_pk_fma_f32 v[26:27], v[26:27], v[114:115], v[118:119]
    v_pk_mul_f32 v[20:21], v[20:21], v[128:129] op_sel:[0,1] op_sel_hi:[1,1]
    v_pk_mul_f32 v[22:23], v[22:23], v[128:129] op_sel:[0,1] op_sel_hi:[1,1]
    v_pk_fma_f32 v[28:29], v[28:29], v[112:113], v[116:117]
    v_pk_fma_f32 v[30:31], v[30:31], v[114:115], v[118:119]
    v_pk_mul_f32 v[24:25], v[24:25], v[130:131] op_sel:[0,0] op_sel_hi:[1,0]
    v_pk_mul_f32 v[26:27], v[26:27], v[130:131] op_sel:[0,0] op_sel_hi:[1,0]
    v_pk_mul_f32 v[28:29], v[28:29], v[130:131] op_sel:[0,1] op_sel_hi:[1,1]
    v_pk_mul_f32 v[30:31], v[30:31], v[130:131] op_sel:[0,1] op_sel_hi:[1,1]
    s_nop 1
    s_waitcnt lgkmcnt(7)
    v_mfma_f32_16x16x32_bf16 v[184:187], v[232:235], a[128:131], v[184:187]
    s_add_u32 m0, s64, 81920
    s_waitcnt vmcnt(8) lgkmcnt(0)
    s_barrier
    v_mfma_f32_16x16x32_bf16 v[184:187], v[236:239], a[144:147], v[184:187]
    buffer_load_dwordx4 v248, s[16:19], s54 offen  lds
    ds_read_b128 v[120:123], v9 offset:6144
    v_mfma_f32_16x16x32_bf16 v[188:191], v[232:235], a[132:135], v[188:191]
    ds_read_b128 v[124:127], v9 offset:6656
    ds_read_b128 v[128:131], v10 offset:1536
    v_mfma_f32_16x16x32_bf16 v[188:191], v[236:239], a[148:151], v[188:191]
    ds_read_b128 a[160:163], v8 offset:16384
    s_add_u32 m0, m0, s40
    v_mfma_f32_16x16x32_bf16 v[192:195], v[232:235], a[136:139], v[192:195]
    buffer_load_dwordx4 v249, s[16:19], s54 offen  lds
    ds_read_b128 a[176:179], v8 offset:24576
    v_mfma_f32_16x16x32_bf16 v[192:195], v[236:239], a[152:155], v[192:195]
    ds_read_b128 v[216:219], v5 offset:0
    ds_read_b128 v[220:223], v6 offset:0
    v_mfma_f32_16x16x32_bf16 v[196:199], v[232:235], a[140:143], v[196:199]
    ds_read_b128 a[164:167], v8 offset:17408
    s_add_u32 m0, m0, s40
    v_mfma_f32_16x16x32_bf16 v[196:199], v[236:239], a[156:159], v[196:199]
    buffer_load_dwordx4 v250, s[16:19], s54 offen  lds
    ds_read_b128 a[180:183], v8 offset:25600
    v_mfma_f32_16x16x32_bf16 v[200:203], v[240:243], a[128:131], v[200:203]
    ds_read_b128 a[168:171], v8 offset:18432
    ds_read_b128 a[184:187], v8 offset:26624
    v_mfma_f32_16x16x32_bf16 v[200:203], v[244:247], a[144:147], v[200:203]
    ds_read_b128 a[172:175], v8 offset:19456
    s_add_u32 m0, m0, s40
    v_mfma_f32_16x16x32_bf16 v[204:207], v[240:243], a[132:135], v[204:207]
    buffer_load_dwordx4 v251, s[16:19], s54 offen  lds
    ds_read_b128 a[188:191], v8 offset:27648
    v_mfma_f32_16x16x32_bf16 v[204:207], v[244:247], a[148:151], v[204:207]
    ds_read_b128 v[224:227], v5 offset:2048
    ds_read_b128 v[228:231], v6 offset:2048
    v_mfma_f32_16x16x32_bf16 v[208:211], v[240:243], a[136:139], v[208:211]
    s_waitcnt lgkmcnt(11)
    ds_read_b128 v[232:235], v5 offset:4096
    v_mfma_f32_16x16x32_bf16 v[208:211], v[244:247], a[152:155], v[208:211]
    buffer_load_dwordx4 v[64:67], v1, s[20:23], s44 offen
    ds_read_b128 v[236:239], v6 offset:4096
    v_mfma_f32_16x16x32_bf16 v[212:215], v[240:243], a[140:143], v[212:215]
    v_cvt_pk_bf16_f32 v136, v16, v20
    v_cvt_pk_bf16_f32 v140, v17, v21
    v_mfma_f32_16x16x32_bf16 v[212:215], v[244:247], a[156:159], v[212:215]
    v_cvt_pk_bf16_f32 v144, v18, v22
    v_cvt_pk_bf16_f32 v148, v19, v23
    v_cvt_pk_bf16_f32 v137, v24, v28
    buffer_load_dwordx4 v[68:71], v1, s[20:23], s45 offen
    v_cvt_pk_bf16_f32 v141, v25, v29
    v_cvt_pk_bf16_f32 v145, v26, v30
    v_cvt_pk_bf16_f32 v149, v27, v31
    s_waitcnt vmcnt(10)
    .p2align 3
    v_cvt_f32_i32 v32, v32
    v_cvt_f32_i32 v33, v33
    v_cvt_f32_i32 v34, v34
    v_cvt_f32_i32 v35, v35
    v_cvt_f32_i32 v36, v36
    v_cvt_f32_i32 v37, v37
    v_cvt_f32_i32 v38, v38
    v_cvt_f32_i32 v39, v39
    v_pk_fma_f32 v[32:33], v[32:33], v[112:113], v[116:117]
    v_pk_fma_f32 v[34:35], v[34:35], v[114:115], v[118:119]
    v_cvt_f32_i32 v40, v40
    v_cvt_f32_i32 v41, v41
    v_cvt_f32_i32 v42, v42
    v_cvt_f32_i32 v43, v43
    v_pk_fma_f32 v[36:37], v[36:37], v[112:113], v[116:117]
    v_pk_fma_f32 v[38:39], v[38:39], v[114:115], v[118:119]
    v_pk_mul_f32 v[32:33], v[32:33], v[132:133] op_sel:[0,0] op_sel_hi:[1,0]
    v_pk_mul_f32 v[34:35], v[34:35], v[132:133] op_sel:[0,0] op_sel_hi:[1,0]
    v_cvt_f32_i32 v44, v44
    v_cvt_f32_i32 v45, v45
    v_cvt_f32_i32 v46, v46
    v_cvt_f32_i32 v47, v47
    v_pk_fma_f32 v[40:41], v[40:41], v[112:113], v[116:117]
    v_pk_fma_f32 v[42:43], v[42:43], v[114:115], v[118:119]
    v_pk_mul_f32 v[36:37], v[36:37], v[132:133] op_sel:[0,1] op_sel_hi:[1,1]
    v_pk_mul_f32 v[38:39], v[38:39], v[132:133] op_sel:[0,1] op_sel_hi:[1,1]
    v_pk_fma_f32 v[44:45], v[44:45], v[112:113], v[116:117]
    v_pk_fma_f32 v[46:47], v[46:47], v[114:115], v[118:119]
    v_pk_mul_f32 v[40:41], v[40:41], v[134:135] op_sel:[0,0] op_sel_hi:[1,0]
    v_pk_mul_f32 v[42:43], v[42:43], v[134:135] op_sel:[0,0] op_sel_hi:[1,0]
    v_pk_mul_f32 v[44:45], v[44:45], v[134:135] op_sel:[0,1] op_sel_hi:[1,1]
    v_pk_mul_f32 v[46:47], v[46:47], v[134:135] op_sel:[0,1] op_sel_hi:[1,1]
    s_nop 1
    s_waitcnt lgkmcnt(4)
    v_mfma_f32_16x16x32_bf16 v[152:155], v[216:219], a[160:163], v[152:155]
    buffer_load_dwordx4 v[72:75], v1, s[20:23], s46 offen
    ds_read_b128 v[132:135], v10 offset:1552
    v_mfma_f32_16x16x32_bf16 v[152:155], v[220:223], a[176:179], v[152:155]
    v_cvt_pk_bf16_f32 v138, v32, v36
    v_cvt_pk_bf16_f32 v139, v40, v44
    v_mfma_f32_16x16x32_bf16 v[156:159], v[216:219], a[164:167], v[156:159]
    ds_write_b128 v7, v[136:139] offset:0
    v_mfma_f32_16x16x32_bf16 v[156:159], v[220:223], a[180:183], v[156:159]
    buffer_load_dwordx4 v[76:79], v1, s[20:23], s47 offen
    ds_read_b128 v[240:243], v5 offset:6144
    v_mfma_f32_16x16x32_bf16 v[160:163], v[216:219], a[168:171], v[160:163]
    v_cvt_pk_bf16_f32 v142, v33, v37
    v_cvt_pk_bf16_f32 v143, v41, v45
    v_mfma_f32_16x16x32_bf16 v[160:163], v[220:223], a[184:187], v[160:163]
    v_cvt_pk_bf16_f32 v146, v34, v38
    v_cvt_pk_bf16_f32 v147, v42, v46
    v_mfma_f32_16x16x32_bf16 v[164:167], v[216:219], a[172:175], v[164:167]
    s_mul_i32 s81, s56, 9216
    v_add_u32 v1, s81, v11
    buffer_load_dwordx4 v[80:83], v1, s[20:23], 0 offen
    v_mfma_f32_16x16x32_bf16 v[164:167], v[220:223], a[188:191], v[164:167]
    ds_write_b128 v7, v[140:143] offset:1024
    s_waitcnt lgkmcnt(6)
    v_mfma_f32_16x16x32_bf16 v[168:171], v[224:227], a[160:163], v[168:171]
    v_cvt_pk_bf16_f32 v150, v35, v39
    v_cvt_pk_bf16_f32 v151, v43, v47
    v_mfma_f32_16x16x32_bf16 v[168:171], v[228:231], a[176:179], v[168:171]
    buffer_load_dwordx4 v[84:87], v1, s[20:23], s41 offen
    ds_read_b128 v[244:247], v6 offset:6144
    v_mfma_f32_16x16x32_bf16 v[172:175], v[224:227], a[164:167], v[172:175]
    ds_write_b128 v7, v[144:147] offset:2048
    v_mfma_f32_16x16x32_bf16 v[172:175], v[228:231], a[180:183], v[172:175]
    v_mfma_f32_16x16x32_bf16 v[176:179], v[224:227], a[168:171], v[176:179]
    buffer_load_dwordx4 v[88:91], v1, s[20:23], s42 offen
    v_mfma_f32_16x16x32_bf16 v[176:179], v[228:231], a[184:187], v[176:179]
    ds_write_b128 v7, v[148:151] offset:3072
    v_mfma_f32_16x16x32_bf16 v[180:183], v[224:227], a[172:175], v[180:183]
    v_mfma_f32_16x16x32_bf16 v[180:183], v[228:231], a[188:191], v[180:183]
    buffer_load_dwordx4 v[92:95], v1, s[20:23], s43 offen
    s_waitcnt vmcnt(12)
    .p2align 3
    v_cvt_f32_i32 v48, v48
    v_cvt_f32_i32 v49, v49
    v_cvt_f32_i32 v50, v50
    v_cvt_f32_i32 v51, v51
    v_cvt_f32_i32 v52, v52
    v_cvt_f32_i32 v53, v53
    v_cvt_f32_i32 v54, v54
    v_cvt_f32_i32 v55, v55
    v_pk_fma_f32 v[48:49], v[48:49], v[120:121], v[124:125]
    v_pk_fma_f32 v[50:51], v[50:51], v[122:123], v[126:127]
    v_cvt_f32_i32 v56, v56
    v_cvt_f32_i32 v57, v57
    v_cvt_f32_i32 v58, v58
    v_cvt_f32_i32 v59, v59
    v_pk_fma_f32 v[52:53], v[52:53], v[120:121], v[124:125]
    v_pk_fma_f32 v[54:55], v[54:55], v[122:123], v[126:127]
    v_pk_mul_f32 v[48:49], v[48:49], v[128:129] op_sel:[0,0] op_sel_hi:[1,0]
    v_pk_mul_f32 v[50:51], v[50:51], v[128:129] op_sel:[0,0] op_sel_hi:[1,0]
    v_cvt_f32_i32 v60, v60
    v_cvt_f32_i32 v61, v61
    v_cvt_f32_i32 v62, v62
    v_cvt_f32_i32 v63, v63
    v_pk_fma_f32 v[56:57], v[56:57], v[120:121], v[124:125]
    v_pk_fma_f32 v[58:59], v[58:59], v[122:123], v[126:127]
    v_pk_mul_f32 v[52:53], v[52:53], v[128:129] op_sel:[0,1] op_sel_hi:[1,1]
    v_pk_mul_f32 v[54:55], v[54:55], v[128:129] op_sel:[0,1] op_sel_hi:[1,1]
    v_pk_fma_f32 v[60:61], v[60:61], v[120:121], v[124:125]
    v_pk_fma_f32 v[62:63], v[62:63], v[122:123], v[126:127]
    v_pk_mul_f32 v[56:57], v[56:57], v[130:131] op_sel:[0,0] op_sel_hi:[1,0]
    v_pk_mul_f32 v[58:59], v[58:59], v[130:131] op_sel:[0,0] op_sel_hi:[1,0]
    v_pk_mul_f32 v[60:61], v[60:61], v[130:131] op_sel:[0,1] op_sel_hi:[1,1]
    v_pk_mul_f32 v[62:63], v[62:63], v[130:131] op_sel:[0,1] op_sel_hi:[1,1]
    s_nop 1
    s_waitcnt lgkmcnt(7)
    v_mfma_f32_16x16x32_bf16 v[184:187], v[232:235], a[160:163], v[184:187]
    s_add_u32 m0, s64, 98304
    s_waitcnt vmcnt(8) lgkmcnt(0)
    s_barrier
    v_mfma_f32_16x16x32_bf16 v[184:187], v[236:239], a[176:179], v[184:187]
    buffer_load_dwordx4 v248, s[16:19], s55 offen  lds
    ds_read_b128 v[112:115], v9 offset:7168
    v_mfma_f32_16x16x32_bf16 v[188:191], v[232:235], a[164:167], v[188:191]
    ds_read_b128 v[116:119], v9 offset:7680
    ds_read_b128 v[128:131], v10 offset:1792
    v_mfma_f32_16x16x32_bf16 v[188:191], v[236:239], a[180:183], v[188:191]
    ds_read_b128 a[192:195], v8 offset:0
    s_add_u32 m0, m0, s40
    v_mfma_f32_16x16x32_bf16 v[192:195], v[232:235], a[168:171], v[192:195]
    buffer_load_dwordx4 v249, s[16:19], s55 offen  lds
    ds_read_b128 a[208:211], v8 offset:8192
    v_mfma_f32_16x16x32_bf16 v[192:195], v[236:239], a[184:187], v[192:195]
    ds_read_b128 v[216:219], v5 offset:16384
    ds_read_b128 v[220:223], v6 offset:16384
    v_mfma_f32_16x16x32_bf16 v[196:199], v[232:235], a[172:175], v[196:199]
    ds_read_b128 a[196:199], v8 offset:1024
    s_add_u32 m0, m0, s40
    v_mfma_f32_16x16x32_bf16 v[196:199], v[236:239], a[188:191], v[196:199]
    buffer_load_dwordx4 v250, s[16:19], s55 offen  lds
    ds_read_b128 a[212:215], v8 offset:9216
    v_mfma_f32_16x16x32_bf16 v[200:203], v[240:243], a[160:163], v[200:203]
    ds_read_b128 a[200:203], v8 offset:2048
    ds_read_b128 a[216:219], v8 offset:10240
    v_mfma_f32_16x16x32_bf16 v[200:203], v[244:247], a[176:179], v[200:203]
    ds_read_b128 a[204:207], v8 offset:3072
    s_add_u32 m0, m0, s40
    v_mfma_f32_16x16x32_bf16 v[204:207], v[240:243], a[164:167], v[204:207]
    buffer_load_dwordx4 v251, s[16:19], s55 offen  lds
    ds_read_b128 a[220:223], v8 offset:11264
    v_mfma_f32_16x16x32_bf16 v[204:207], v[244:247], a[180:183], v[204:207]
    ds_read_b128 v[224:227], v5 offset:18432
    ds_read_b128 v[228:231], v6 offset:18432
    v_mfma_f32_16x16x32_bf16 v[208:211], v[240:243], a[168:171], v[208:211]
    s_waitcnt lgkmcnt(11)
    ds_read_b128 v[232:235], v5 offset:20480
    v_mfma_f32_16x16x32_bf16 v[208:211], v[244:247], a[184:187], v[208:211]
    buffer_load_dwordx4 v[96:99], v1, s[20:23], s44 offen
    ds_read_b128 v[236:239], v6 offset:20480
    v_mfma_f32_16x16x32_bf16 v[212:215], v[240:243], a[172:175], v[212:215]
    v_cvt_pk_bf16_f32 v136, v48, v52
    v_cvt_pk_bf16_f32 v140, v49, v53
    v_mfma_f32_16x16x32_bf16 v[212:215], v[244:247], a[188:191], v[212:215]
    v_cvt_pk_bf16_f32 v144, v50, v54
    v_cvt_pk_bf16_f32 v148, v51, v55
    v_cvt_pk_bf16_f32 v137, v56, v60
    buffer_load_dwordx4 v[100:103], v1, s[20:23], s45 offen
    v_cvt_pk_bf16_f32 v141, v57, v61
    v_cvt_pk_bf16_f32 v145, v58, v62
    v_cvt_pk_bf16_f32 v149, v59, v63
    s_waitcnt vmcnt(10)
    .p2align 3
    v_cvt_f32_i32 v64, v64
    v_cvt_f32_i32 v65, v65
    v_cvt_f32_i32 v66, v66
    v_cvt_f32_i32 v67, v67
    v_cvt_f32_i32 v68, v68
    v_cvt_f32_i32 v69, v69
    v_cvt_f32_i32 v70, v70
    v_cvt_f32_i32 v71, v71
    v_pk_fma_f32 v[64:65], v[64:65], v[120:121], v[124:125]
    v_pk_fma_f32 v[66:67], v[66:67], v[122:123], v[126:127]
    v_cvt_f32_i32 v72, v72
    v_cvt_f32_i32 v73, v73
    v_cvt_f32_i32 v74, v74
    v_cvt_f32_i32 v75, v75
    v_pk_fma_f32 v[68:69], v[68:69], v[120:121], v[124:125]
    v_pk_fma_f32 v[70:71], v[70:71], v[122:123], v[126:127]
    v_pk_mul_f32 v[64:65], v[64:65], v[132:133] op_sel:[0,0] op_sel_hi:[1,0]
    v_pk_mul_f32 v[66:67], v[66:67], v[132:133] op_sel:[0,0] op_sel_hi:[1,0]
    v_cvt_f32_i32 v76, v76
    v_cvt_f32_i32 v77, v77
    v_cvt_f32_i32 v78, v78
    v_cvt_f32_i32 v79, v79
    v_pk_fma_f32 v[72:73], v[72:73], v[120:121], v[124:125]
    v_pk_fma_f32 v[74:75], v[74:75], v[122:123], v[126:127]
    v_pk_mul_f32 v[68:69], v[68:69], v[132:133] op_sel:[0,1] op_sel_hi:[1,1]
    v_pk_mul_f32 v[70:71], v[70:71], v[132:133] op_sel:[0,1] op_sel_hi:[1,1]
    v_pk_fma_f32 v[76:77], v[76:77], v[120:121], v[124:125]
    v_pk_fma_f32 v[78:79], v[78:79], v[122:123], v[126:127]
    v_pk_mul_f32 v[72:73], v[72:73], v[134:135] op_sel:[0,0] op_sel_hi:[1,0]
    v_pk_mul_f32 v[74:75], v[74:75], v[134:135] op_sel:[0,0] op_sel_hi:[1,0]
    v_pk_mul_f32 v[76:77], v[76:77], v[134:135] op_sel:[0,1] op_sel_hi:[1,1]
    v_pk_mul_f32 v[78:79], v[78:79], v[134:135] op_sel:[0,1] op_sel_hi:[1,1]
    s_nop 1
    s_waitcnt lgkmcnt(4)
    v_mfma_f32_16x16x32_bf16 v[152:155], v[216:219], a[192:195], v[152:155]
    buffer_load_dwordx4 v[104:107], v1, s[20:23], s46 offen
    ds_read_b128 v[132:135], v10 offset:1808
    v_mfma_f32_16x16x32_bf16 v[152:155], v[220:223], a[208:211], v[152:155]
    v_cvt_pk_bf16_f32 v138, v64, v68
    v_cvt_pk_bf16_f32 v139, v72, v76
    v_mfma_f32_16x16x32_bf16 v[156:159], v[216:219], a[196:199], v[156:159]
    ds_write_b128 v7, v[136:139] offset:16384
    v_mfma_f32_16x16x32_bf16 v[156:159], v[220:223], a[212:215], v[156:159]
    buffer_load_dwordx4 v[108:111], v1, s[20:23], s47 offen
    ds_read_b128 v[240:243], v5 offset:22528
    v_mfma_f32_16x16x32_bf16 v[160:163], v[216:219], a[200:203], v[160:163]
    v_cvt_pk_bf16_f32 v142, v65, v69
    v_cvt_pk_bf16_f32 v143, v73, v77
    v_mfma_f32_16x16x32_bf16 v[160:163], v[220:223], a[216:219], v[160:163]
    v_cvt_pk_bf16_f32 v146, v66, v70
    v_cvt_pk_bf16_f32 v147, v74, v78
    v_mfma_f32_16x16x32_bf16 v[164:167], v[216:219], a[204:207], v[164:167]
    s_add_u32 m0, s64, 114688
    ds_write_b128 v7, v[140:143] offset:17408
    v_mfma_f32_16x16x32_bf16 v[164:167], v[220:223], a[220:223], v[164:167]
    buffer_load_dwordx4 v248, s[16:19], s56 offen  lds
    ds_read_b128 v[244:247], v6 offset:22528
    s_waitcnt lgkmcnt(7)
    v_mfma_f32_16x16x32_bf16 v[168:171], v[224:227], a[192:195], v[168:171]
    v_cvt_pk_bf16_f32 v150, v67, v71
    v_cvt_pk_bf16_f32 v151, v75, v79
    v_mfma_f32_16x16x32_bf16 v[168:171], v[228:231], a[208:211], v[168:171]
    s_add_u32 m0, m0, s40
    ds_write_b128 v7, v[144:147] offset:18432
    v_mfma_f32_16x16x32_bf16 v[172:175], v[224:227], a[196:199], v[172:175]
    buffer_load_dwordx4 v249, s[16:19], s56 offen  lds
    v_mfma_f32_16x16x32_bf16 v[172:175], v[228:231], a[212:215], v[172:175]
    v_mfma_f32_16x16x32_bf16 v[176:179], v[224:227], a[200:203], v[176:179]
    ds_write_b128 v7, v[148:151] offset:19456
    v_mfma_f32_16x16x32_bf16 v[176:179], v[228:231], a[216:219], v[176:179]
    s_add_u32 m0, m0, s40
    v_mfma_f32_16x16x32_bf16 v[180:183], v[224:227], a[204:207], v[180:183]
    buffer_load_dwordx4 v250, s[16:19], s56 offen  lds
    v_mfma_f32_16x16x32_bf16 v[180:183], v[228:231], a[220:223], v[180:183]
    s_waitcnt vmcnt(11)
    .p2align 3
    v_cvt_f32_i32 v80, v80
    v_cvt_f32_i32 v81, v81
    v_cvt_f32_i32 v82, v82
    v_cvt_f32_i32 v83, v83
    v_cvt_f32_i32 v84, v84
    v_cvt_f32_i32 v85, v85
    v_cvt_f32_i32 v86, v86
    v_cvt_f32_i32 v87, v87
    v_pk_fma_f32 v[80:81], v[80:81], v[112:113], v[116:117]
    v_pk_fma_f32 v[82:83], v[82:83], v[114:115], v[118:119]
    v_cvt_f32_i32 v88, v88
    v_cvt_f32_i32 v89, v89
    v_cvt_f32_i32 v90, v90
    v_cvt_f32_i32 v91, v91
    v_pk_fma_f32 v[84:85], v[84:85], v[112:113], v[116:117]
    v_pk_fma_f32 v[86:87], v[86:87], v[114:115], v[118:119]
    v_pk_mul_f32 v[80:81], v[80:81], v[128:129] op_sel:[0,0] op_sel_hi:[1,0]
    v_pk_mul_f32 v[82:83], v[82:83], v[128:129] op_sel:[0,0] op_sel_hi:[1,0]
    v_cvt_f32_i32 v92, v92
    v_cvt_f32_i32 v93, v93
    v_cvt_f32_i32 v94, v94
    v_cvt_f32_i32 v95, v95
    v_pk_fma_f32 v[88:89], v[88:89], v[112:113], v[116:117]
    v_pk_fma_f32 v[90:91], v[90:91], v[114:115], v[118:119]
    v_pk_mul_f32 v[84:85], v[84:85], v[128:129] op_sel:[0,1] op_sel_hi:[1,1]
    v_pk_mul_f32 v[86:87], v[86:87], v[128:129] op_sel:[0,1] op_sel_hi:[1,1]
    v_pk_fma_f32 v[92:93], v[92:93], v[112:113], v[116:117]
    v_pk_fma_f32 v[94:95], v[94:95], v[114:115], v[118:119]
    v_pk_mul_f32 v[88:89], v[88:89], v[130:131] op_sel:[0,0] op_sel_hi:[1,0]
    v_pk_mul_f32 v[90:91], v[90:91], v[130:131] op_sel:[0,0] op_sel_hi:[1,0]
    v_pk_mul_f32 v[92:93], v[92:93], v[130:131] op_sel:[0,1] op_sel_hi:[1,1]
    v_pk_mul_f32 v[94:95], v[94:95], v[130:131] op_sel:[0,1] op_sel_hi:[1,1]
    s_nop 1
    s_waitcnt lgkmcnt(7)
    v_mfma_f32_16x16x32_bf16 v[184:187], v[232:235], a[192:195], v[184:187]
    s_add_u32 m0, m0, s40
    s_branch L_seg_B7
    .p2align 12
L_pad_B7:
    s_setpc_b64 s[78:79]
L_seg_B7:
    v_mfma_f32_16x16x32_bf16 v[184:187], v[236:239], a[208:211], v[184:187]
    buffer_load_dwordx4 v251, s[16:19], s56 offen  lds
    s_waitcnt vmcnt(8) lgkmcnt(0)
    s_barrier
    v_mfma_f32_16x16x32_bf16 v[188:191], v[232:235], a[196:199], v[188:191]
    ds_read_b128 a[224:227], v8 offset:16384
    ds_read_b128 a[240:243], v8 offset:24576
    v_mfma_f32_16x16x32_bf16 v[188:191], v[236:239], a[212:215], v[188:191]
    s_add_u32 m0, s65, 0
    ds_read_b128 v[216:219], v5 offset:32768
    v_mfma_f32_16x16x32_bf16 v[192:195], v[232:235], a[200:203], v[192:195]
    v_add_u32 v248, s4, v2
    buffer_load_dwordx4 v248, s[16:19], s48 offen  lds
    v_mfma_f32_16x16x32_bf16 v[192:195], v[236:239], a[216:219], v[192:195]
    ds_read_b128 v[220:223], v6 offset:32768
    ds_read_b128 a[228:231], v8 offset:17408
    v_mfma_f32_16x16x32_bf16 v[196:199], v[232:235], a[204:207], v[196:199]
    s_add_u32 m0, m0, s40
    ds_read_b128 a[244:247], v8 offset:25600
    v_mfma_f32_16x16x32_bf16 v[196:199], v[236:239], a[220:223], v[196:199]
    buffer_load_dwordx4 v248, s[16:19], s49 offen  lds
    ds_read_b128 a[232:235], v8 offset:18432
    v_mfma_f32_16x16x32_bf16 v[200:203], v[240:243], a[192:195], v[200:203]
    ds_read_b128 a[248:251], v8 offset:26624
    ds_read_b128 a[236:239], v8 offset:19456
    v_mfma_f32_16x16x32_bf16 v[200:203], v[244:247], a[208:211], v[200:203]
    s_add_u32 m0, m0, s40
    ds_read_b128 a[252:255], v8 offset:27648
    v_mfma_f32_16x16x32_bf16 v[204:207], v[240:243], a[196:199], v[204:207]
    buffer_load_dwordx4 v248, s[16:19], s50 offen  lds
    ds_read_b128 v[224:227], v5 offset:34816
    v_mfma_f32_16x16x32_bf16 v[204:207], v[244:247], a[212:215], v[204:207]
    ds_read_b128 v[228:231], v6 offset:34816
    ds_read_b128 v[232:235], v5 offset:36864
    v_mfma_f32_16x16x32_bf16 v[208:211], v[240:243], a[200:203], v[208:211]
    s_add_u32 m0, m0, s40
    ds_read_b128 v[236:239], v6 offset:36864
    v_mfma_f32_16x16x32_bf16 v[208:211], v[244:247], a[216:219], v[208:211]
    buffer_load_dwordx4 v248, s[16:19], s51 offen  lds
    v_mfma_f32_16x16x32_bf16 v[212:215], v[240:243], a[204:207], v[212:215]
    v_cvt_pk_bf16_f32 v136, v80, v84
    v_cvt_pk_bf16_f32 v140, v81, v85
    v_mfma_f32_16x16x32_bf16 v[212:215], v[244:247], a[220:223], v[212:215]
    s_add_u32 m0, m0, s40
    v_cvt_pk_bf16_f32 v144, v82, v86
    buffer_load_dwordx4 v248, s[16:19], s52 offen  lds
    v_cvt_pk_bf16_f32 v148, v83, v87
    v_cvt_pk_bf16_f32 v137, v88, v92
    v_cvt_pk_bf16_f32 v141, v89, v93
    v_cvt_pk_bf16_f32 v145, v90, v94
    v_cvt_pk_bf16_f32 v149, v91, v95
    s_add_u32 m0, m0, s40
    s_waitcnt vmcnt(9)
    .p2align 3
    v_cvt_f32_i32 v96, v96
    v_cvt_f32_i32 v97, v97
    v_cvt_f32_i32 v98, v98
    v_cvt_f32_i32 v99, v99
    v_cvt_f32_i32 v100, v100
    v_cvt_f32_i32 v101, v101
    v_cvt_f32_i32 v102, v102
    v_cvt_f32_i32 v103, v103
    v_pk_fma_f32 v[96:97], v[96:97], v[112:113], v[116:117]
    v_pk_fma_f32 v[98:99], v[98:99], v[114:115], v[118:119]
    v_cvt_f32_i32 v104, v104
    v_cvt_f32_i32 v105, v105
    v_cvt_f32_i32 v106, v106
    v_cvt_f32_i32 v107, v107
    v_pk_fma_f32 v[100:101], v[100:101], v[112:113], v[116:117]
    v_pk_fma_f32 v[102:103], v[102:103], v[114:115], v[118:119]
    v_pk_mul_f32 v[96:97], v[96:97], v[132:133] op_sel:[0,0] op_sel_hi:[1,0]
    v_pk_mul_f32 v[98:99], v[98:99], v[132:133] op_sel:[0,0] op_sel_hi:[1,0]
    v_cvt_f32_i32 v108, v108
    v_cvt_f32_i32 v109, v109
    v_cvt_f32_i32 v110, v110
    v_cvt_f32_i32 v111, v111
    v_pk_fma_f32 v[104:105], v[104:105], v[112:113], v[116:117]
    v_pk_fma_f32 v[106:107], v[106:107], v[114:115], v[118:119]
    v_pk_mul_f32 v[100:101], v[100:101], v[132:133] op_sel:[0,1] op_sel_hi:[1,1]
    v_pk_mul_f32 v[102:103], v[102:103], v[132:133] op_sel:[0,1] op_sel_hi:[1,1]
    v_pk_fma_f32 v[108:109], v[108:109], v[112:113], v[116:117]
    v_pk_fma_f32 v[110:111], v[110:111], v[114:115], v[118:119]
    v_pk_mul_f32 v[104:105], v[104:105], v[134:135] op_sel:[0,0] op_sel_hi:[1,0]
    v_pk_mul_f32 v[106:107], v[106:107], v[134:135] op_sel:[0,0] op_sel_hi:[1,0]
    v_pk_mul_f32 v[108:109], v[108:109], v[134:135] op_sel:[0,1] op_sel_hi:[1,1]
    v_pk_mul_f32 v[110:111], v[110:111], v[134:135] op_sel:[0,1] op_sel_hi:[1,1]
    s_nop 1
    s_waitcnt lgkmcnt(4)
    v_mfma_f32_16x16x32_bf16 v[152:155], v[216:219], a[224:227], v[152:155]
    buffer_load_dwordx4 v248, s[16:19], s53 offen  lds
    ds_read_b128 v[240:243], v5 offset:38912
    v_mfma_f32_16x16x32_bf16 v[152:155], v[220:223], a[240:243], v[152:155]
    v_cvt_pk_bf16_f32 v138, v96, v100
    v_cvt_pk_bf16_f32 v139, v104, v108
    v_mfma_f32_16x16x32_bf16 v[156:159], v[216:219], a[228:231], v[156:159]
    s_add_u32 m0, m0, s40
    ds_write_b128 v7, v[136:139] offset:0
    v_mfma_f32_16x16x32_bf16 v[156:159], v[220:223], a[244:247], v[156:159]
    buffer_load_dwordx4 v248, s[16:19], s54 offen  lds
    ds_read_b128 v[244:247], v6 offset:38912
    v_mfma_f32_16x16x32_bf16 v[160:163], v[216:219], a[232:235], v[160:163]
    v_cvt_pk_bf16_f32 v142, v97, v101
    v_cvt_pk_bf16_f32 v143, v105, v109
    v_mfma_f32_16x16x32_bf16 v[160:163], v[220:223], a[248:251], v[160:163]
    s_add_u32 m0, m0, s40
    ds_write_b128 v7, v[140:143] offset:1024
    v_mfma_f32_16x16x32_bf16 v[164:167], v[216:219], a[236:239], v[164:167]
    buffer_load_dwordx4 v248, s[16:19], s55 offen  lds
    v_mfma_f32_16x16x32_bf16 v[164:167], v[220:223], a[252:255], v[164:167]
    v_cvt_pk_bf16_f32 v146, v98, v102
    v_cvt_pk_bf16_f32 v147, v106, v110
    s_waitcnt lgkmcnt(6)
    v_mfma_f32_16x16x32_bf16 v[168:171], v[224:227], a[224:227], v[168:171]
    s_add_u32 m0, m0, s40
    ds_write_b128 v7, v[144:147] offset:2048
    v_mfma_f32_16x16x32_bf16 v[168:171], v[228:231], a[240:243], v[168:171]
    buffer_load_dwordx4 v248, s[16:19], s56 offen  lds
    v_mfma_f32_16x16x32_bf16 v[172:175], v[224:227], a[228:231], v[172:175]
    v_cvt_pk_bf16_f32 v150, v99, v103
    v_cvt_pk_bf16_f32 v151, v107, v111
    v_mfma_f32_16x16x32_bf16 v[172:175], v[228:231], a[244:247], v[172:175]
    ds_write_b128 v7, v[148:151] offset:3072
    v_mfma_f32_16x16x32_bf16 v[176:179], v[224:227], a[232:235], v[176:179]
    v_mfma_f32_16x16x32_bf16 v[176:179], v[228:231], a[248:251], v[176:179]
    v_mfma_f32_16x16x32_bf16 v[180:183], v[224:227], a[236:239], v[180:183]
    v_mfma_f32_16x16x32_bf16 v[180:183], v[228:231], a[252:255], v[180:183]
    s_waitcnt lgkmcnt(6)
    v_mfma_f32_16x16x32_bf16 v[184:187], v[232:235], a[224:227], v[184:187]
    v_mfma_f32_16x16x32_bf16 v[184:187], v[236:239], a[240:243], v[184:187]
    v_mfma_f32_16x16x32_bf16 v[188:191], v[232:235], a[228:231], v[188:191]
    v_mfma_f32_16x16x32_bf16 v[188:191], v[236:239], a[244:247], v[188:191]
    v_mfma_f32_16x16x32_bf16 v[192:195], v[232:235], a[232:235], v[192:195]
    s_waitcnt vmcnt(9) lgkmcnt(0)
    s_barrier
    v_mfma_f32_16x16x32_bf16 v[192:195], v[236:239], a[248:251], v[192:195]
    s_add_u32 m0, s65, 36864
    ds_read_b128 v[16:19], v8 offset:0
    v_mfma_f32_16x16x32_bf16 v[196:199], v[232:235], a[236:239], v[196:199]
    v_add_u32 v248, s5, v2
    buffer_load_dwordx4 v248, s[16:19], s48 offen  lds
    v_mfma_f32_16x16x32_bf16 v[196:199], v[236:239], a[252:255], v[196:199]
    ds_read_b128 v[32:35], v8 offset:8192
    ds_read_b128 v[216:219], v5 offset:49152
    v_mfma_f32_16x16x32_bf16 v[200:203], v[240:243], a[224:227], v[200:203]
    ds_read_b128 v[220:223], v6 offset:49152
    ds_read_b128 v[20:23], v8 offset:1024
    v_mfma_f32_16x16x32_bf16 v[200:203], v[244:247], a[240:243], v[200:203]
    ds_read_b128 v[36:39], v8 offset:9216
    ds_read_b128 v[24:27], v8 offset:2048
    v_mfma_f32_16x16x32_bf16 v[204:207], v[240:243], a[228:231], v[204:207]
    s_add_u32 m0, m0, s40
    ds_read_b128 v[40:43], v8 offset:10240
    v_mfma_f32_16x16x32_bf16 v[204:207], v[244:247], a[244:247], v[204:207]
    buffer_load_dwordx4 v248, s[16:19], s49 offen  lds
    ds_read_b128 v[28:31], v8 offset:3072
    v_mfma_f32_16x16x32_bf16 v[208:211], v[240:243], a[232:235], v[208:211]
    ds_read_b128 v[44:47], v8 offset:11264
    ds_read_b128 v[224:227], v5 offset:51200
    v_mfma_f32_16x16x32_bf16 v[208:211], v[244:247], a[248:251], v[208:211]
    ds_read_b128 v[228:231], v6 offset:51200
    ds_read_b128 v[232:235], v5 offset:53248
    v_mfma_f32_16x16x32_bf16 v[212:215], v[240:243], a[236:239], v[212:215]
    ds_read_b128 v[236:239], v6 offset:53248
    v_mfma_f32_16x16x32_bf16 v[212:215], v[244:247], a[252:255], v[212:215]
    s_add_u32 m0, m0, s40
    s_waitcnt lgkmcnt(4)
    v_mfma_f32_16x16x32_bf16 v[152:155], v[216:219], v[16:19], v[152:155]
    buffer_load_dwordx4 v248, s[16:19], s50 offen  lds
    ds_read_b128 v[240:243], v5 offset:55296
    v_mfma_f32_16x16x32_bf16 v[152:155], v[220:223], v[32:35], v[152:155]
    ds_read_b128 v[244:247], v6 offset:55296
    s_mul_i32 s74, s68, 10240
    v_mfma_f32_16x16x32_bf16 v[156:159], v[216:219], v[20:23], v[156:159]
    v_add_u32 v3, s74, v3
    v_add_u32 v4, s74, v4
    v_mfma_f32_16x16x32_bf16 v[156:159], v[220:223], v[36:39], v[156:159]
    v_add_u32 v5, s74, v5
    v_add_u32 v6, s74, v6
    v_mfma_f32_16x16x32_bf16 v[160:163], v[216:219], v[24:27], v[160:163]
    s_add_u32 m0, m0, s40
    v_mfma_f32_16x16x32_bf16 v[160:163], v[220:223], v[40:43], v[160:163]
    buffer_load_dwordx4 v248, s[16:19], s51 offen  lds
    v_mfma_f32_16x16x32_bf16 v[164:167], v[216:219], v[28:31], v[164:167]
    v_mfma_f32_16x16x32_bf16 v[164:167], v[220:223], v[44:47], v[164:167]
    s_waitcnt lgkmcnt(4)
    v_mfma_f32_16x16x32_bf16 v[168:171], v[224:227], v[16:19], v[168:171]
    v_mfma_f32_16x16x32_bf16 v[168:171], v[228:231], v[32:35], v[168:171]
    s_add_u32 m0, m0, s40
    v_mfma_f32_16x16x32_bf16 v[172:175], v[224:227], v[20:23], v[172:175]
    buffer_load_dwordx4 v248, s[16:19], s52 offen  lds
    v_mfma_f32_16x16x32_bf16 v[172:175], v[228:231], v[36:39], v[172:175]
    v_mfma_f32_16x16x32_bf16 v[176:179], v[224:227], v[24:27], v[176:179]
    v_mfma_f32_16x16x32_bf16 v[176:179], v[228:231], v[40:43], v[176:179]
    v_mfma_f32_16x16x32_bf16 v[180:183], v[224:227], v[28:31], v[180:183]
    s_add_u32 m0, m0, s40
    v_mfma_f32_16x16x32_bf16 v[180:183], v[228:231], v[44:47], v[180:183]
    buffer_load_dwordx4 v248, s[16:19], s53 offen  lds
    s_waitcnt lgkmcnt(2)
    v_mfma_f32_16x16x32_bf16 v[184:187], v[232:235], v[16:19], v[184:187]
    v_mfma_f32_16x16x32_bf16 v[184:187], v[236:239], v[32:35], v[184:187]
    v_mfma_f32_16x16x32_bf16 v[188:191], v[232:235], v[20:23], v[188:191]
    v_mfma_f32_16x16x32_bf16 v[188:191], v[236:239], v[36:39], v[188:191]
    s_add_u32 m0, m0, s40
    v_mfma_f32_16x16x32_bf16 v[192:195], v[232:235], v[24:27], v[192:195]
    buffer_load_dwordx4 v248, s[16:19], s54 offen  lds
    v_mfma_f32_16x16x32_bf16 v[192:195], v[236:239], v[40:43], v[192:195]
    v_mfma_f32_16x16x32_bf16 v[196:199], v[232:235], v[28:31], v[196:199]
    v_mfma_f32_16x16x32_bf16 v[196:199], v[236:239], v[44:47], v[196:199]
    s_waitcnt vmcnt(7) lgkmcnt(0)
    s_barrier
    v_mfma_f32_16x16x32_bf16 v[200:203], v[240:243], v[16:19], v[200:203]
    s_add_u32 m0, m0, s40
    ds_read_b128 v[216:219], v3 offset:0
    v_mfma_f32_16x16x32_bf16 v[200:203], v[244:247], v[32:35], v[200:203]
    buffer_load_dwordx4 v248, s[16:19], s55 offen  lds
    v_mfma_f32_16x16x32_bf16 v[204:207], v[240:243], v[20:23], v[204:207]
    ds_read_b128 v[220:223], v4 offset:0
    v_mfma_f32_16x16x32_bf16 v[204:207], v[244:247], v[36:39], v[204:207]
    ds_read_b128 v[224:227], v3 offset:2048
    v_mfma_f32_16x16x32_bf16 v[208:211], v[240:243], v[24:27], v[208:211]
    ds_read_b128 v[228:231], v4 offset:2048
    v_mfma_f32_16x16x32_bf16 v[208:211], v[244:247], v[40:43], v[208:211]
    s_add_u32 m0, m0, s40
    ds_read_b128 v[232:235], v3 offset:4096
    v_mfma_f32_16x16x32_bf16 v[212:215], v[240:243], v[28:31], v[212:215]
    buffer_load_dwordx4 v248, s[16:19], s56 offen  lds
    v_mfma_f32_16x16x32_bf16 v[212:215], v[244:247], v[44:47], v[212:215]
    ds_read_b128 v[236:239], v4 offset:4096
    s_waitcnt lgkmcnt(4)
    v_mfma_f32_16x16x32_bf16 v[48:51], v[216:219], a[0:3], 0
    buffer_load_dwordx2 v[254:255], v252, s[16:19], s9 offen
    v_mfma_f32_16x16x32_bf16 v[48:51], v[220:223], a[16:19], v[48:51]
    ds_read_b128 v[240:243], v3 offset:6144
    v_mfma_f32_16x16x32_bf16 v[52:55], v[216:219], a[4:7], 0
    ds_read_b128 v[244:247], v4 offset:6144
    v_mfma_f32_16x16x32_bf16 v[52:55], v[220:223], a[20:23], v[52:55]
    v_mfma_f32_16x16x32_bf16 v[56:59], v[216:219], a[8:11], 0
    v_mfma_f32_16x16x32_bf16 v[56:59], v[220:223], a[24:27], v[56:59]
    v_mfma_f32_16x16x32_bf16 v[60:63], v[216:219], a[12:15], 0
    s_add_u32 m0, s65, 73728
    v_mfma_f32_16x16x32_bf16 v[60:63], v[220:223], a[28:31], v[60:63]
    v_add_u32 v248, s6, v2
    buffer_load_dwordx4 v248, s[16:19], s48 offen  lds
    s_waitcnt lgkmcnt(4)
    v_mfma_f32_16x16x32_bf16 v[48:51], v[224:227], a[32:35], v[48:51]
    ds_read_b128 v[216:219], v3 offset:8192
    v_mfma_f32_16x16x32_bf16 v[48:51], v[228:231], a[48:51], v[48:51]
    ds_read_b128 v[220:223], v4 offset:8192
    v_mfma_f32_16x16x32_bf16 v[52:55], v[224:227], a[36:39], v[52:55]
    v_mfma_f32_16x16x32_bf16 v[52:55], v[228:231], a[52:55], v[52:55]
    s_add_u32 m0, m0, s40
    v_mfma_f32_16x16x32_bf16 v[56:59], v[224:227], a[40:43], v[56:59]
    buffer_load_dwordx4 v248, s[16:19], s49 offen  lds
    v_mfma_f32_16x16x32_bf16 v[56:59], v[228:231], a[56:59], v[56:59]
    v_mfma_f32_16x16x32_bf16 v[60:63], v[224:227], a[44:47], v[60:63]
    v_mfma_f32_16x16x32_bf16 v[60:63], v[228:231], a[60:63], v[60:63]
    s_waitcnt lgkmcnt(4)
    v_mfma_f32_16x16x32_bf16 v[48:51], v[232:235], a[64:67], v[48:51]
    s_add_u32 m0, m0, s40
    ds_read_b128 v[224:227], v3 offset:10240
    v_mfma_f32_16x16x32_bf16 v[48:51], v[236:239], a[80:83], v[48:51]
    buffer_load_dwordx4 v248, s[16:19], s50 offen  lds
    v_mfma_f32_16x16x32_bf16 v[52:55], v[232:235], a[68:71], v[52:55]
    ds_read_b128 v[228:231], v4 offset:10240
    v_mfma_f32_16x16x32_bf16 v[52:55], v[236:239], a[84:87], v[52:55]
    v_mfma_f32_16x16x32_bf16 v[56:59], v[232:235], a[72:75], v[56:59]
    v_mfma_f32_16x16x32_bf16 v[56:59], v[236:239], a[88:91], v[56:59]
    s_add_u32 m0, m0, s40
    v_mfma_f32_16x16x32_bf16 v[60:63], v[232:235], a[76:79], v[60:63]
    buffer_load_dwordx4 v248, s[16:19], s51 offen  lds
    v_mfma_f32_16x16x32_bf16 v[60:63], v[236:239], a[92:95], v[60:63]
    s_waitcnt lgkmcnt(4)
    v_mfma_f32_16x16x32_bf16 v[48:51], v[240:243], a[96:99], v[48:51]
    ds_read_b128 v[232:235], v3 offset:12288
    v_mfma_f32_16x16x32_bf16 v[48:51], v[244:247], a[112:115], v[48:51]
    ds_read_b128 v[236:239], v4 offset:12288
    v_mfma_f32_16x16x32_bf16 v[52:55], v[240:243], a[100:103], v[52:55]
    s_add_u32 m0, m0, s40
    v_mfma_f32_16x16x32_bf16 v[52:55], v[244:247], a[116:119], v[52:55]
    buffer_load_dwordx4 v248, s[16:19], s52 offen  lds
    v_mfma_f32_16x16x32_bf16 v[56:59], v[240:243], a[104:107], v[56:59]
    v_mfma_f32_16x16x32_bf16 v[56:59], v[244:247], a[120:123], v[56:59]
    v_mfma_f32_16x16x32_bf16 v[60:63], v[240:243], a[108:111], v[60:63]
    v_mfma_f32_16x16x32_bf16 v[60:63], v[244:247], a[124:127], v[60:63]
    s_add_u32 m0, m0, s40
    s_waitcnt lgkmcnt(4)
    v_mfma_f32_16x16x32_bf16 v[48:51], v[216:219], a[128:131], v[48:51]
    buffer_load_dwordx4 v248, s[16:19], s53 offen  lds
    v_mfma_f32_16x16x32_bf16 v[48:51], v[220:223], a[144:147], v[48:51]
    ds_read_b128 v[240:243], v3 offset:14336
    v_mfma_f32_16x16x32_bf16 v[52:55], v[216:219], a[132:135], v[52:55]
    ds_read_b128 v[244:247], v4 offset:14336
    v_mfma_f32_16x16x32_bf16 v[52:55], v[220:223], a[148:151], v[52:55]
    v_mfma_f32_16x16x32_bf16 v[56:59], v[216:219], a[136:139], v[56:59]
    s_add_u32 m0, m0, s40
    v_mfma_f32_16x16x32_bf16 v[56:59], v[220:223], a[152:155], v[56:59]
    buffer_load_dwordx4 v248, s[16:19], s54 offen  lds
    v_mfma_f32_16x16x32_bf16 v[60:63], v[216:219], a[140:143], v[60:63]
    v_mfma_f32_16x16x32_bf16 v[60:63], v[220:223], a[156:159], v[60:63]
    s_waitcnt lgkmcnt(4)
    v_mfma_f32_16x16x32_bf16 v[48:51], v[224:227], a[160:163], v[48:51]
    ds_read_b128 v[216:219], v3 offset:16384
    v_mfma_f32_16x16x32_bf16 v[48:51], v[228:231], a[176:179], v[48:51]
    s_add_u32 m0, m0, s40
    ds_read_b128 v[220:223], v4 offset:16384
    v_mfma_f32_16x16x32_bf16 v[52:55], v[224:227], a[164:167], v[52:55]
    buffer_load_dwordx4 v248, s[16:19], s55 offen  lds
    v_mfma_f32_16x16x32_bf16 v[52:55], v[228:231], a[180:183], v[52:55]
    v_mfma_f32_16x16x32_bf16 v[56:59], v[224:227], a[168:171], v[56:59]
    v_mfma_f32_16x16x32_bf16 v[56:59], v[228:231], a[184:187], v[56:59]
    v_mfma_f32_16x16x32_bf16 v[60:63], v[224:227], a[172:175], v[60:63]
    s_add_u32 m0, m0, s40
    v_mfma_f32_16x16x32_bf16 v[60:63], v[228:231], a[188:191], v[60:63]
    buffer_load_dwordx4 v248, s[16:19], s56 offen  lds
    s_waitcnt lgkmcnt(4)
    v_mfma_f32_16x16x32_bf16 v[48:51], v[232:235], a[192:195], v[48:51]
    v_mfma_f32_16x16x32_bf16 v[48:51], v[236:239], a[208:211], v[48:51]
    v_mfma_f32_16x16x32_bf16 v[52:55], v[232:235], a[196:199], v[52:55]
    v_mfma_f32_16x16x32_bf16 v[52:55], v[236:239], a[212:215], v[52:55]
    v_mfma_f32_16x16x32_bf16 v[56:59], v[232:235], a[200:203], v[56:59]
    v_mfma_f32_16x16x32_bf16 v[56:59], v[236:239], a[216:219], v[56:59]
    v_mfma_f32_16x16x32_bf16 v[60:63], v[232:235], a[204:207], v[60:63]
    v_mfma_f32_16x16x32_bf16 v[60:63], v[236:239], a[220:223], v[60:63]
    s_waitcnt vmcnt(10) lgkmcnt(0)
    s_barrier
    v_mfma_f32_16x16x32_bf16 v[48:51], v[240:243], a[224:227], v[48:51]
    s_add_u32 m0, s65, 0
    ds_read_b128 v[224:227], v3 offset:36864
    v_mfma_f32_16x16x32_bf16 v[48:51], v[244:247], a[240:243], v[48:51]
    v_add_u32 v248, s7, v2
    buffer_load_dwordx4 v248, s[16:19], s48 offen  lds
    v_mfma_f32_16x16x32_bf16 v[52:55], v[240:243], a[228:231], v[52:55]
    ds_read_b128 v[228:231], v4 offset:36864
    v_mfma_f32_16x16x32_bf16 v[52:55], v[244:247], a[244:247], v[52:55]
    ds_read_b128 v[232:235], v3 offset:38912
    v_mfma_f32_16x16x32_bf16 v[56:59], v[240:243], a[232:235], v[56:59]
    ds_read_b128 v[236:239], v4 offset:38912
    v_mfma_f32_16x16x32_bf16 v[56:59], v[244:247], a[248:251], v[56:59]
    s_add_u32 m0, m0, s40
    s_lshl_b32 s57, s4, 3
    v_mfma_f32_16x16x32_bf16 v[60:63], v[240:243], a[236:239], v[60:63]
    buffer_load_dwordx4 v248, s[16:19], s49 offen  lds
    v_mfma_f32_16x16x32_bf16 v[60:63], v[244:247], a[252:255], v[60:63]
    v_mfma_f32_16x16x32_bf16 v[48:51], v[216:219], v[16:19], v[48:51]
    ds_read_b128 v[240:243], v3 offset:40960
    v_mfma_f32_16x16x32_bf16 v[48:51], v[220:223], v[32:35], v[48:51]
    ds_read_b128 v[244:247], v4 offset:40960
    v_mfma_f32_16x16x32_bf16 v[52:55], v[216:219], v[20:23], v[52:55]
    s_add_u32 m0, m0, s40
    v_mfma_f32_16x16x32_bf16 v[52:55], v[220:223], v[36:39], v[52:55]
    buffer_load_dwordx4 v248, s[16:19], s50 offen  lds
    v_mfma_f32_16x16x32_bf16 v[56:59], v[216:219], v[24:27], v[56:59]
    v_mfma_f32_16x16x32_bf16 v[56:59], v[220:223], v[40:43], v[56:59]
    v_mfma_f32_16x16x32_bf16 v[60:63], v[216:219], v[28:31], v[60:63]
    v_mfma_f32_16x16x32_bf16 v[60:63], v[220:223], v[44:47], v[60:63]
    s_add_u32 m0, m0, s40
    s_waitcnt lgkmcnt(4)
    v_mfma_f32_16x16x32_bf16 v[64:67], v[224:227], a[0:3], 0
    buffer_load_dwordx4 v248, s[16:19], s51 offen  lds
    v_mfma_f32_16x16x32_bf16 v[64:67], v[228:231], a[16:19], v[64:67]
    ds_read_b128 v[216:219], v3 offset:43008
    v_mfma_f32_16x16x32_bf16 v[68:71], v[224:227], a[4:7], 0
    ds_read_b128 v[220:223], v4 offset:43008
    v_mfma_f32_16x16x32_bf16 v[68:71], v[228:231], a[20:23], v[68:71]
    v_cvt_pk_bf16_f32 v144, v48, v52
    v_mfma_f32_16x16x32_bf16 v[72:75], v[224:227], a[8:11], 0
    s_add_u32 m0, m0, s40
    v_cvt_pk_bf16_f32 v145, v56, v60
    v_mfma_f32_16x16x32_bf16 v[72:75], v[228:231], a[24:27], v[72:75]
    buffer_load_dwordx4 v248, s[16:19], s52 offen  lds
    v_mfma_f32_16x16x32_bf16 v[76:79], v[224:227], a[12:15], 0
    v_cvt_pk_bf16_f32 v146, v49, v53
    v_mfma_f32_16x16x32_bf16 v[76:79], v[228:231], a[28:31], v[76:79]
    v_cvt_pk_bf16_f32 v147, v57, v61
    s_waitcnt lgkmcnt(4)
    v_mfma_f32_16x16x32_bf16 v[64:67], v[232:235], a[32:35], v[64:67]
    ds_read_b128 v[224:227], v3 offset:45056
    v_mfma_f32_16x16x32_bf16 v[64:67], v[236:239], a[48:51], v[64:67]
    s_add_u32 m0, m0, s40
    ds_read_b128 v[228:231], v4 offset:45056
    v_mfma_f32_16x16x32_bf16 v[68:71], v[232:235], a[36:39], v[68:71]
    buffer_load_dwordx4 v248, s[16:19], s53 offen  lds
    v_mfma_f32_16x16x32_bf16 v[68:71], v[236:239], a[52:55], v[68:71]
    v_cvt_pk_bf16_f32 v148, v50, v54
    v_mfma_f32_16x16x32_bf16 v[72:75], v[232:235], a[40:43], v[72:75]
    v_cvt_pk_bf16_f32 v149, v58, v62
    v_mfma_f32_16x16x32_bf16 v[72:75], v[236:239], a[56:59], v[72:75]
    v_cvt_pk_bf16_f32 v150, v51, v55
    v_mfma_f32_16x16x32_bf16 v[76:79], v[232:235], a[44:47], v[76:79]
    s_add_u32 m0, m0, s40
    v_cvt_pk_bf16_f32 v151, v59, v63
    v_mfma_f32_16x16x32_bf16 v[76:79], v[236:239], a[60:63], v[76:79]
    buffer_load_dwordx4 v248, s[16:19], s54 offen  lds
    s_waitcnt lgkmcnt(4)
    v_mfma_f32_16x16x32_bf16 v[64:67], v[240:243], a[64:67], v[64:67]
    ds_read_b128 v[232:235], v3 offset:47104
    v_mfma_f32_16x16x32_bf16 v[64:67], v[244:247], a[80:83], v[64:67]
    ds_read_b128 v[236:239], v4 offset:47104
    v_mfma_f32_16x16x32_bf16 v[68:71], v[240:243], a[68:71], v[68:71]
    v_cvt_pk_bf16_f32 v136, v152, v156
    v_mfma_f32_16x16x32_bf16 v[68:71], v[244:247], a[84:87], v[68:71]
    s_add_u32 m0, m0, s40
    v_cvt_pk_bf16_f32 v137, v160, v164
    v_mfma_f32_16x16x32_bf16 v[72:75], v[240:243], a[72:75], v[72:75]
    buffer_load_dwordx4 v248, s[16:19], s55 offen  lds
    v_mfma_f32_16x16x32_bf16 v[72:75], v[244:247], a[88:91], v[72:75]
    v_cvt_pk_bf16_f32 v138, v153, v157
    v_mfma_f32_16x16x32_bf16 v[76:79], v[240:243], a[76:79], v[76:79]
    v_cvt_pk_bf16_f32 v139, v161, v165
    v_mfma_f32_16x16x32_bf16 v[76:79], v[244:247], a[92:95], v[76:79]
    v_cvt_pk_bf16_f32 v140, v154, v158
    s_waitcnt lgkmcnt(4)
    v_mfma_f32_16x16x32_bf16 v[64:67], v[216:219], a[96:99], v[64:67]
    s_add_u32 m0, m0, s40
    ds_read_b128 v[240:243], v3 offset:49152
    v_mfma_f32_16x16x32_bf16 v[64:67], v[220:223], a[112:115], v[64:67]
    buffer_load_dwordx4 v248, s[16:19], s56 offen  lds
    v_mfma_f32_16x16x32_bf16 v[68:71], v[216:219], a[100:103], v[68:71]
    ds_read_b128 v[244:247], v4 offset:49152
    v_mfma_f32_16x16x32_bf16 v[68:71], v[220:223], a[116:119], v[68:71]
    v_cvt_pk_bf16_f32 v141, v162, v166
    v_mfma_f32_16x16x32_bf16 v[72:75], v[216:219], a[104:107], v[72:75]
    v_cvt_pk_bf16_f32 v142, v155, v159
    v_mfma_f32_16x16x32_bf16 v[72:75], v[220:223], a[120:123], v[72:75]
    buffer_store_dwordx2 v[144:145], v12, s[36:39], s57 offen nt
    v_mfma_f32_16x16x32_bf16 v[76:79], v[216:219], a[108:111], v[76:79]
    v_cvt_pk_bf16_f32 v143, v163, v167
    v_mfma_f32_16x16x32_bf16 v[76:79], v[220:223], a[124:127], v[76:79]
    s_waitcnt lgkmcnt(4)
    v_mfma_f32_16x16x32_bf16 v[64:67], v[224:227], a[128:131], v[64:67]
    ds_read_b128 v[216:219], v3 offset:51200
    v_mfma_f32_16x16x32_bf16 v[64:67], v[228:231], a[144:147], v[64:67]
    buffer_store_dwordx2 v[146:147], v13, s[36:39], s57 offen nt
    v_mfma_f32_16x16x32_bf16 v[68:71], v[224:227], a[132:135], v[68:71]
    ds_read_b128 v[220:223], v4 offset:51200
    v_mfma_f32_16x16x32_bf16 v[68:71], v[228:231], a[148:151], v[68:71]
    v_mfma_f32_16x16x32_bf16 v[72:75], v[224:227], a[136:139], v[72:75]
    v_mfma_f32_16x16x32_bf16 v[72:75], v[228:231], a[152:155], v[72:75]
    buffer_store_dwordx2 v[148:149], v14, s[36:39], s57 offen nt
    v_mfma_f32_16x16x32_bf16 v[76:79], v[224:227], a[140:143], v[76:79]
    v_mfma_f32_16x16x32_bf16 v[76:79], v[228:231], a[156:159], v[76:79]
    s_waitcnt lgkmcnt(4)
    v_mfma_f32_16x16x32_bf16 v[64:67], v[232:235], a[160:163], v[64:67]
    ds_read_b128 v[224:227], v3 offset:53248
    v_mfma_f32_16x16x32_bf16 v[64:67], v[236:239], a[176:179], v[64:67]
    buffer_store_dwordx2 v[150:151], v15, s[36:39], s57 offen nt
    v_mfma_f32_16x16x32_bf16 v[68:71], v[232:235], a[164:167], v[68:71]
    ds_read_b128 v[228:231], v4 offset:53248
    v_mfma_f32_16x16x32_bf16 v[68:71], v[236:239], a[180:183], v[68:71]
    v_mfma_f32_16x16x32_bf16 v[72:75], v[232:235], a[168:171], v[72:75]
    v_mfma_f32_16x16x32_bf16 v[72:75], v[236:239], a[184:187], v[72:75]
    buffer_store_dwordx2 v[136:137], v12, s[36:39], s71 offen nt
    v_mfma_f32_16x16x32_bf16 v[76:79], v[232:235], a[172:175], v[76:79]
    v_mfma_f32_16x16x32_bf16 v[76:79], v[236:239], a[188:191], v[76:79]
    s_waitcnt lgkmcnt(4)
    v_mfma_f32_16x16x32_bf16 v[64:67], v[240:243], a[192:195], v[64:67]
    v_mfma_f32_16x16x32_bf16 v[64:67], v[244:247], a[208:211], v[64:67]
    buffer_store_dwordx2 v[138:139], v13, s[36:39], s71 offen nt
    v_mfma_f32_16x16x32_bf16 v[68:71], v[240:243], a[196:199], v[68:71]
    v_mfma_f32_16x16x32_bf16 v[68:71], v[244:247], a[212:215], v[68:71]
    v_mfma_f32_16x16x32_bf16 v[72:75], v[240:243], a[200:203], v[72:75]
    v_mfma_f32_16x16x32_bf16 v[72:75], v[244:247], a[216:219], v[72:75]
    buffer_store_dwordx2 v[140:141], v14, s[36:39], s71 offen nt
    v_mfma_f32_16x16x32_bf16 v[76:79], v[240:243], a[204:207], v[76:79]
    v_mfma_f32_16x16x32_bf16 v[76:79], v[244:247], a[220:223], v[76:79]
    s_branch L_seg_V2
    .p2align 12
L_pad_V2:
    s_setpc_b64 s[78:79]
L_seg_V2:
    s_waitcnt lgkmcnt(2)
    v_mfma_f32_16x16x32_bf16 v[64:67], v[216:219], a[224:227], v[64:67]
    s_waitcnt vmcnt(16) lgkmcnt(0)
    s_barrier
    v_mfma_f32_16x16x32_bf16 v[64:67], v[220:223], a[240:243], v[64:67]
    buffer_store_dwordx2 v[142:143], v15, s[36:39], s71 offen nt
    v_mfma_f32_16x16x32_bf16 v[68:71], v[216:219], a[228:231], v[68:71]
    ds_read_b128 v[232:235], v5 offset:8192
    v_mfma_f32_16x16x32_bf16 v[68:71], v[220:223], a[244:247], v[68:71]
    ds_read_b128 v[236:239], v6 offset:8192
    v_mfma_f32_16x16x32_bf16 v[72:75], v[216:219], a[232:235], v[72:75]
    ds_read_b128 v[240:243], v5 offset:10240
    v_mfma_f32_16x16x32_bf16 v[72:75], v[220:223], a[248:251], v[72:75]
    s_add_u32 m0, s65, 36864
    ds_read_b128 v[244:247], v6 offset:10240
    v_mfma_f32_16x16x32_bf16 v[76:79], v[216:219], a[236:239], v[76:79]
    v_add_u32 v248, s8, v2
    buffer_load_dwordx4 v248, s[16:19], s48 offen  lds
    v_mfma_f32_16x16x32_bf16 v[76:79], v[220:223], a[252:255], v[76:79]
    s_lshl_b32 s57, s5, 3
    v_mfma_f32_16x16x32_bf16 v[64:67], v[224:227], v[16:19], v[64:67]
    ds_read_b128 v[216:219], v5 offset:12288
    v_mfma_f32_16x16x32_bf16 v[64:67], v[228:231], v[32:35], v[64:67]
    ds_read_b128 v[220:223], v6 offset:12288
    v_mfma_f32_16x16x32_bf16 v[68:71], v[224:227], v[20:23], v[68:71]
    s_add_u32 m0, m0, s40
    v_mfma_f32_16x16x32_bf16 v[68:71], v[228:231], v[36:39], v[68:71]
    buffer_load_dwordx4 v248, s[16:19], s49 offen  lds
    v_mfma_f32_16x16x32_bf16 v[72:75], v[224:227], v[24:27], v[72:75]
    v_mfma_f32_16x16x32_bf16 v[72:75], v[228:231], v[40:43], v[72:75]
    v_mfma_f32_16x16x32_bf16 v[76:79], v[224:227], v[28:31], v[76:79]
    v_mfma_f32_16x16x32_bf16 v[76:79], v[228:231], v[44:47], v[76:79]
    s_add_u32 m0, m0, s40
    s_waitcnt lgkmcnt(4)
    v_mfma_f32_16x16x32_bf16 v[48:51], v[232:235], a[0:3], 0
    buffer_load_dwordx4 v248, s[16:19], s50 offen  lds
    v_mfma_f32_16x16x32_bf16 v[48:51], v[236:239], a[16:19], v[48:51]
    ds_read_b128 v[224:227], v5 offset:14336
    v_mfma_f32_16x16x32_bf16 v[52:55], v[232:235], a[4:7], 0
    ds_read_b128 v[228:231], v6 offset:14336
    v_mfma_f32_16x16x32_bf16 v[52:55], v[236:239], a[20:23], v[52:55]
    v_cvt_pk_bf16_f32 v144, v64, v68
    v_mfma_f32_16x16x32_bf16 v[56:59], v[232:235], a[8:11], 0
    s_add_u32 m0, m0, s40
    v_cvt_pk_bf16_f32 v145, v72, v76
    v_mfma_f32_16x16x32_bf16 v[56:59], v[236:239], a[24:27], v[56:59]
    buffer_load_dwordx4 v248, s[16:19], s51 offen  lds
    v_mfma_f32_16x16x32_bf16 v[60:63], v[232:235], a[12:15], 0
    v_cvt_pk_bf16_f32 v146, v65, v69
    v_mfma_f32_16x16x32_bf16 v[60:63], v[236:239], a[28:31], v[60:63]
    v_cvt_pk_bf16_f32 v147, v73, v77
    s_waitcnt lgkmcnt(4)
    v_mfma_f32_16x16x32_bf16 v[48:51], v[240:243], a[32:35], v[48:51]
    ds_read_b128 v[232:235], v5 offset:16384
    v_mfma_f32_16x16x32_bf16 v[48:51], v[244:247], a[48:51], v[48:51]
    s_add_u32 m0, m0, s40
    ds_read_b128 v[236:239], v6 offset:16384
    v_mfma_f32_16x16x32_bf16 v[52:55], v[240:243], a[36:39], v[52:55]
    buffer_load_dwordx4 v248, s[16:19], s52 offen  lds
    v_mfma_f32_16x16x32_bf16 v[52:55], v[244:247], a[52:55], v[52:55]
    v_cvt_pk_bf16_f32 v148, v66, v70
    v_mfma_f32_16x16x32_bf16 v[56:59], v[240:243], a[40:43], v[56:59]
    v_cvt_pk_bf16_f32 v149, v74, v78
    v_mfma_f32_16x16x32_bf16 v[56:59], v[244:247], a[56:59], v[56:59]
    v_cvt_pk_bf16_f32 v150, v67, v71
    v_mfma_f32_16x16x32_bf16 v[60:63], v[240:243], a[44:47], v[60:63]
    s_add_u32 m0, m0, s40
    v_cvt_pk_bf16_f32 v151, v75, v79
    v_mfma_f32_16x16x32_bf16 v[60:63], v[244:247], a[60:63], v[60:63]
    buffer_load_dwordx4 v248, s[16:19], s53 offen  lds
    s_waitcnt lgkmcnt(4)
    v_mfma_f32_16x16x32_bf16 v[48:51], v[216:219], a[64:67], v[48:51]
    ds_read_b128 v[240:243], v5 offset:18432
    v_mfma_f32_16x16x32_bf16 v[48:51], v[220:223], a[80:83], v[48:51]
    ds_read_b128 v[244:247], v6 offset:18432
    v_mfma_f32_16x16x32_bf16 v[52:55], v[216:219], a[68:71], v[52:55]
    s_add_u32 s71, s71, 147456
    v_cvt_pk_bf16_f32 v136, v168, v172
    v_mfma_f32_16x16x32_bf16 v[52:55], v[220:223], a[84:87], v[52:55]
    s_add_u32 m0, m0, s40
    v_cvt_pk_bf16_f32 v137, v176, v180
    v_mfma_f32_16x16x32_bf16 v[56:59], v[216:219], a[72:75], v[56:59]
    buffer_load_dwordx4 v248, s[16:19], s54 offen  lds
    v_mfma_f32_16x16x32_bf16 v[56:59], v[220:223], a[88:91], v[56:59]
    v_cvt_pk_bf16_f32 v138, v169, v173
    v_mfma_f32_16x16x32_bf16 v[60:63], v[216:219], a[76:79], v[60:63]
    v_cvt_pk_bf16_f32 v139, v177, v181
    v_mfma_f32_16x16x32_bf16 v[60:63], v[220:223], a[92:95], v[60:63]
    v_cvt_pk_bf16_f32 v140, v170, v174
    s_waitcnt lgkmcnt(4)
    v_mfma_f32_16x16x32_bf16 v[48:51], v[224:227], a[96:99], v[48:51]
    s_add_u32 m0, m0, s40
    ds_read_b128 v[216:219], v5 offset:20480
    v_mfma_f32_16x16x32_bf16 v[48:51], v[228:231], a[112:115], v[48:51]
    buffer_load_dwordx4 v248, s[16:19], s55 offen  lds
    v_mfma_f32_16x16x32_bf16 v[52:55], v[224:227], a[100:103], v[52:55]
    ds_read_b128 v[220:223], v6 offset:20480
    v_mfma_f32_16x16x32_bf16 v[52:55], v[228:231], a[116:119], v[52:55]
    v_cvt_pk_bf16_f32 v141, v178, v182
    v_mfma_f32_16x16x32_bf16 v[56:59], v[224:227], a[104:107], v[56:59]
    v_cvt_pk_bf16_f32 v142, v171, v175
    v_mfma_f32_16x16x32_bf16 v[56:59], v[228:231], a[120:123], v[56:59]
    s_add_u32 m0, m0, s40
    v_cvt_pk_bf16_f32 v143, v179, v183
    v_mfma_f32_16x16x32_bf16 v[60:63], v[224:227], a[108:111], v[60:63]
    buffer_load_dwordx4 v248, s[16:19], s56 offen  lds
    v_mfma_f32_16x16x32_bf16 v[60:63], v[228:231], a[124:127], v[60:63]
    s_waitcnt lgkmcnt(4)
    v_mfma_f32_16x16x32_bf16 v[48:51], v[232:235], a[128:131], v[48:51]
    ds_read_b128 v[224:227], v5 offset:22528
    v_mfma_f32_16x16x32_bf16 v[48:51], v[236:239], a[144:147], v[48:51]
    ds_read_b128 v[228:231], v6 offset:22528
    v_mfma_f32_16x16x32_bf16 v[52:55], v[232:235], a[132:135], v[52:55]
    buffer_store_dwordx2 v[144:145], v12, s[36:39], s57 offen nt
    v_mfma_f32_16x16x32_bf16 v[52:55], v[236:239], a[148:151], v[52:55]
    v_mfma_f32_16x16x32_bf16 v[56:59], v[232:235], a[136:139], v[56:59]
    v_mfma_f32_16x16x32_bf16 v[56:59], v[236:239], a[152:155], v[56:59]
    v_mfma_f32_16x16x32_bf16 v[60:63], v[232:235], a[140:143], v[60:63]
    buffer_store_dwordx2 v[146:147], v13, s[36:39], s57 offen nt
    v_mfma_f32_16x16x32_bf16 v[60:63], v[236:239], a[156:159], v[60:63]
    s_waitcnt lgkmcnt(4)
    v_mfma_f32_16x16x32_bf16 v[48:51], v[240:243], a[160:163], v[48:51]
    ds_read_b128 v[232:235], v5 offset:24576
    v_mfma_f32_16x16x32_bf16 v[48:51], v[244:247], a[176:179], v[48:51]
    ds_read_b128 v[236:239], v6 offset:24576
    v_mfma_f32_16x16x32_bf16 v[52:55], v[240:243], a[164:167], v[52:55]
    buffer_store_dwordx2 v[148:149], v14, s[36:39], s57 offen nt
    v_mfma_f32_16x16x32_bf16 v[52:55], v[244:247], a[180:183], v[52:55]
    v_mfma_f32_16x16x32_bf16 v[56:59], v[240:243], a[168:171], v[56:59]
    v_mfma_f32_16x16x32_bf16 v[56:59], v[244:247], a[184:187], v[56:59]
    v_mfma_f32_16x16x32_bf16 v[60:63], v[240:243], a[172:175], v[60:63]
    buffer_store_dwordx2 v[150:151], v15, s[36:39], s57 offen nt
    v_mfma_f32_16x16x32_bf16 v[60:63], v[244:247], a[188:191], v[60:63]
    s_waitcnt lgkmcnt(4)
    v_mfma_f32_16x16x32_bf16 v[48:51], v[216:219], a[192:195], v[48:51]
    v_mfma_f32_16x16x32_bf16 v[48:51], v[220:223], a[208:211], v[48:51]
    v_mfma_f32_16x16x32_bf16 v[52:55], v[216:219], a[196:199], v[52:55]
    buffer_store_dwordx2 v[136:137], v12, s[36:39], s71 offen nt
    v_mfma_f32_16x16x32_bf16 v[52:55], v[220:223], a[212:215], v[52:55]
    v_mfma_f32_16x16x32_bf16 v[56:59], v[216:219], a[200:203], v[56:59]
    v_mfma_f32_16x16x32_bf16 v[56:59], v[220:223], a[216:219], v[56:59]
    v_mfma_f32_16x16x32_bf16 v[60:63], v[216:219], a[204:207], v[60:63]
    buffer_store_dwordx2 v[138:139], v13, s[36:39], s71 offen nt
    v_mfma_f32_16x16x32_bf16 v[60:63], v[220:223], a[220:223], v[60:63]
    s_waitcnt vmcnt(23) lgkmcnt(0)
    s_barrier
    v_mfma_f32_16x16x32_bf16 v[48:51], v[224:227], a[224:227], v[48:51]
    ds_read_b128 v[240:243], v3 offset:0
    v_mfma_f32_16x16x32_bf16 v[48:51], v[228:231], a[240:243], v[48:51]
    ds_read_b128 v[244:247], v4 offset:0
    v_mfma_f32_16x16x32_bf16 v[52:55], v[224:227], a[228:231], v[52:55]
    buffer_store_dwordx2 v[140:141], v14, s[36:39], s71 offen nt
    v_mfma_f32_16x16x32_bf16 v[52:55], v[228:231], a[244:247], v[52:55]
    ds_read_b128 v[216:219], v3 offset:2048
    v_mfma_f32_16x16x32_bf16 v[56:59], v[224:227], a[232:235], v[56:59]
    ds_read_b128 v[220:223], v4 offset:2048
    v_mfma_f32_16x16x32_bf16 v[56:59], v[228:231], a[248:251], v[56:59]
    s_lshl_b32 s57, s6, 3
    v_mfma_f32_16x16x32_bf16 v[60:63], v[224:227], a[236:239], v[60:63]
    buffer_store_dwordx2 v[142:143], v15, s[36:39], s71 offen nt
    v_mfma_f32_16x16x32_bf16 v[60:63], v[228:231], a[252:255], v[60:63]
    v_mfma_f32_16x16x32_bf16 v[48:51], v[232:235], v[16:19], v[48:51]
    ds_read_b128 v[224:227], v3 offset:4096
    v_mfma_f32_16x16x32_bf16 v[48:51], v[236:239], v[32:35], v[48:51]
    ds_read_b128 v[228:231], v4 offset:4096
    v_mfma_f32_16x16x32_bf16 v[52:55], v[232:235], v[20:23], v[52:55]
    s_add_u32 m0, s65, 73728
    v_mfma_f32_16x16x32_bf16 v[52:55], v[236:239], v[36:39], v[52:55]
    v_add_u32 v248, s9, v2
    buffer_load_dwordx4 v248, s[16:19], s48 offen  lds
    v_mfma_f32_16x16x32_bf16 v[56:59], v[232:235], v[24:27], v[56:59]
    v_mfma_f32_16x16x32_bf16 v[56:59], v[236:239], v[40:43], v[56:59]
    v_mfma_f32_16x16x32_bf16 v[60:63], v[232:235], v[28:31], v[60:63]
    v_mfma_f32_16x16x32_bf16 v[60:63], v[236:239], v[44:47], v[60:63]
    s_add_u32 m0, m0, s40
    s_waitcnt lgkmcnt(4)
    v_mfma_f32_16x16x32_bf16 v[64:67], v[240:243], a[0:3], 0
    buffer_load_dwordx4 v248, s[16:19], s49 offen  lds
    v_mfma_f32_16x16x32_bf16 v[64:67], v[244:247], a[16:19], v[64:67]
    ds_read_b128 v[232:235], v3 offset:6144
    v_mfma_f32_16x16x32_bf16 v[68:71], v[240:243], a[4:7], 0
    ds_read_b128 v[236:239], v4 offset:6144
    v_mfma_f32_16x16x32_bf16 v[68:71], v[244:247], a[20:23], v[68:71]
    v_cvt_pk_bf16_f32 v144, v48, v52
    v_mfma_f32_16x16x32_bf16 v[72:75], v[240:243], a[8:11], 0
    s_add_u32 m0, m0, s40
    v_cvt_pk_bf16_f32 v145, v56, v60
    v_mfma_f32_16x16x32_bf16 v[72:75], v[244:247], a[24:27], v[72:75]
    buffer_load_dwordx4 v248, s[16:19], s50 offen  lds
    v_mfma_f32_16x16x32_bf16 v[76:79], v[240:243], a[12:15], 0
    v_cvt_pk_bf16_f32 v146, v49, v53
    v_mfma_f32_16x16x32_bf16 v[76:79], v[244:247], a[28:31], v[76:79]
    v_cvt_pk_bf16_f32 v147, v57, v61
    s_waitcnt lgkmcnt(4)
    v_mfma_f32_16x16x32_bf16 v[64:67], v[216:219], a[32:35], v[64:67]
    ds_read_b128 v[240:243], v3 offset:8192
    v_mfma_f32_16x16x32_bf16 v[64:67], v[220:223], a[48:51], v[64:67]
    s_add_u32 m0, m0, s40
    ds_read_b128 v[244:247], v4 offset:8192
    v_mfma_f32_16x16x32_bf16 v[68:71], v[216:219], a[36:39], v[68:71]
    buffer_load_dwordx4 v248, s[16:19], s51 offen  lds
    v_mfma_f32_16x16x32_bf16 v[68:71], v[220:223], a[52:55], v[68:71]
    v_cvt_pk_bf16_f32 v148, v50, v54
    v_mfma_f32_16x16x32_bf16 v[72:75], v[216:219], a[40:43], v[72:75]
    v_cvt_pk_bf16_f32 v149, v58, v62
    v_mfma_f32_16x16x32_bf16 v[72:75], v[220:223], a[56:59], v[72:75]
    v_cvt_pk_bf16_f32 v150, v51, v55
    v_mfma_f32_16x16x32_bf16 v[76:79], v[216:219], a[44:47], v[76:79]
    s_add_u32 m0, m0, s40
    v_cvt_pk_bf16_f32 v151, v59, v63
    v_mfma_f32_16x16x32_bf16 v[76:79], v[220:223], a[60:63], v[76:79]
    buffer_load_dwordx4 v248, s[16:19], s52 offen  lds
    s_waitcnt lgkmcnt(4)
    v_mfma_f32_16x16x32_bf16 v[64:67], v[224:227], a[64:67], v[64:67]
    ds_read_b128 v[216:219], v3 offset:10240
    v_mfma_f32_16x16x32_bf16 v[64:67], v[228:231], a[80:83], v[64:67]
    ds_read_b128 v[220:223], v4 offset:10240
    v_mfma_f32_16x16x32_bf16 v[68:71], v[224:227], a[68:71], v[68:71]
    s_add_u32 s71, s71, 147456
    v_cvt_pk_bf16_f32 v136, v184, v188
    v_mfma_f32_16x16x32_bf16 v[68:71], v[228:231], a[84:87], v[68:71]
    s_add_u32 m0, m0, s40
    v_cvt_pk_bf16_f32 v137, v192, v196
    v_mfma_f32_16x16x32_bf16 v[72:75], v[224:227], a[72:75], v[72:75]
    buffer_load_dwordx4 v248, s[16:19], s53 offen  lds
    v_mfma_f32_16x16x32_bf16 v[72:75], v[228:231], a[88:91], v[72:75]
    v_cvt_pk_bf16_f32 v138, v185, v189
    v_mfma_f32_16x16x32_bf16 v[76:79], v[224:227], a[76:79], v[76:79]
    v_cvt_pk_bf16_f32 v139, v193, v197
    v_mfma_f32_16x16x32_bf16 v[76:79], v[228:231], a[92:95], v[76:79]
    v_cvt_pk_bf16_f32 v140, v186, v190
    s_waitcnt lgkmcnt(4)
    v_mfma_f32_16x16x32_bf16 v[64:67], v[232:235], a[96:99], v[64:67]
    s_add_u32 m0, m0, s40
    ds_read_b128 v[224:227], v3 offset:12288
    v_mfma_f32_16x16x32_bf16 v[64:67], v[236:239], a[112:115], v[64:67]
    buffer_load_dwordx4 v248, s[16:19], s54 offen  lds
    v_mfma_f32_16x16x32_bf16 v[68:71], v[232:235], a[100:103], v[68:71]
    ds_read_b128 v[228:231], v4 offset:12288
    v_mfma_f32_16x16x32_bf16 v[68:71], v[236:239], a[116:119], v[68:71]
    v_cvt_pk_bf16_f32 v141, v194, v198
    v_mfma_f32_16x16x32_bf16 v[72:75], v[232:235], a[104:107], v[72:75]
    v_cvt_pk_bf16_f32 v142, v187, v191
    v_mfma_f32_16x16x32_bf16 v[72:75], v[236:239], a[120:123], v[72:75]
    s_add_u32 m0, m0, s40
    v_cvt_pk_bf16_f32 v143, v195, v199
    v_mfma_f32_16x16x32_bf16 v[76:79], v[232:235], a[108:111], v[76:79]
    buffer_load_dwordx4 v248, s[16:19], s55 offen  lds
    v_mfma_f32_16x16x32_bf16 v[76:79], v[236:239], a[124:127], v[76:79]
    s_waitcnt lgkmcnt(4)
    v_mfma_f32_16x16x32_bf16 v[64:67], v[240:243], a[128:131], v[64:67]
    ds_read_b128 v[232:235], v3 offset:14336
    v_mfma_f32_16x16x32_bf16 v[64:67], v[244:247], a[144:147], v[64:67]
    ds_read_b128 v[236:239], v4 offset:14336
    v_mfma_f32_16x16x32_bf16 v[68:71], v[240:243], a[132:135], v[68:71]
    s_add_u32 m0, m0, s40
    v_mfma_f32_16x16x32_bf16 v[68:71], v[244:247], a[148:151], v[68:71]
    buffer_load_dwordx4 v248, s[16:19], s56 offen  lds
    v_mfma_f32_16x16x32_bf16 v[72:75], v[240:243], a[136:139], v[72:75]
    v_mfma_f32_16x16x32_bf16 v[72:75], v[244:247], a[152:155], v[72:75]
    v_mfma_f32_16x16x32_bf16 v[76:79], v[240:243], a[140:143], v[76:79]
    v_mfma_f32_16x16x32_bf16 v[76:79], v[244:247], a[156:159], v[76:79]
    buffer_store_dwordx2 v[144:145], v12, s[36:39], s57 offen nt
    s_waitcnt lgkmcnt(4)
    v_mfma_f32_16x16x32_bf16 v[64:67], v[216:219], a[160:163], v[64:67]
    ds_read_b128 v[240:243], v3 offset:16384
    v_mfma_f32_16x16x32_bf16 v[64:67], v[220:223], a[176:179], v[64:67]
    ds_read_b128 v[244:247], v4 offset:16384
    v_mfma_f32_16x16x32_bf16 v[68:71], v[216:219], a[164:167], v[68:71]
    v_mfma_f32_16x16x32_bf16 v[68:71], v[220:223], a[180:183], v[68:71]
    buffer_store_dwordx2 v[146:147], v13, s[36:39], s57 offen nt
    v_mfma_f32_16x16x32_bf16 v[72:75], v[216:219], a[168:171], v[72:75]
    v_mfma_f32_16x16x32_bf16 v[72:75], v[220:223], a[184:187], v[72:75]
    v_mfma_f32_16x16x32_bf16 v[76:79], v[216:219], a[172:175], v[76:79]
    v_mfma_f32_16x16x32_bf16 v[76:79], v[220:223], a[188:191], v[76:79]
    buffer_store_dwordx2 v[148:149], v14, s[36:39], s57 offen nt
    s_waitcnt lgkmcnt(4)
    v_mfma_f32_16x16x32_bf16 v[64:67], v[224:227], a[192:195], v[64:67]
    v_mfma_f32_16x16x32_bf16 v[64:67], v[228:231], a[208:211], v[64:67]
    v_mfma_f32_16x16x32_bf16 v[68:71], v[224:227], a[196:199], v[68:71]
    v_mfma_f32_16x16x32_bf16 v[68:71], v[228:231], a[212:215], v[68:71]
    buffer_store_dwordx2 v[150:151], v15, s[36:39], s57 offen nt
    v_mfma_f32_16x16x32_bf16 v[72:75], v[224:227], a[200:203], v[72:75]
    v_mfma_f32_16x16x32_bf16 v[72:75], v[228:231], a[216:219], v[72:75]
    v_mfma_f32_16x16x32_bf16 v[76:79], v[224:227], a[204:207], v[76:79]
    v_mfma_f32_16x16x32_bf16 v[76:79], v[228:231], a[220:223], v[76:79]
    buffer_store_dwordx2 v[136:137], v12, s[36:39], s71 offen nt
    s_waitcnt lgkmcnt(2)
    v_mfma_f32_16x16x32_bf16 v[64:67], v[232:235], a[224:227], v[64:67]
    s_waitcnt vmcnt(22) lgkmcnt(0)
    s_barrier
    v_mfma_f32_16x16x32_bf16 v[64:67], v[236:239], a[240:243], v[64:67]
    ds_read_b128 v[216:219], v3 offset:36864
    v_mfma_f32_16x16x32_bf16 v[68:71], v[232:235], a[228:231], v[68:71]
    ds_read_b128 v[220:223], v4 offset:36864
    v_mfma_f32_16x16x32_bf16 v[68:71], v[236:239], a[244:247], v[68:71]
    buffer_store_dwordx2 v[138:139], v13, s[36:39], s71 offen nt
    v_mfma_f32_16x16x32_bf16 v[72:75], v[232:235], a[232:235], v[72:75]
    ds_read_b128 v[224:227], v3 offset:38912
    v_mfma_f32_16x16x32_bf16 v[72:75], v[236:239], a[248:251], v[72:75]
    ds_read_b128 v[228:231], v4 offset:38912
    v_mfma_f32_16x16x32_bf16 v[76:79], v[232:235], a[236:239], v[76:79]
    s_lshl_b32 s57, s7, 3
    v_mfma_f32_16x16x32_bf16 v[76:79], v[236:239], a[252:255], v[76:79]
    buffer_store_dwordx2 v[140:141], v14, s[36:39], s71 offen nt
    v_mfma_f32_16x16x32_bf16 v[64:67], v[240:243], v[16:19], v[64:67]
    ds_read_b128 v[232:235], v3 offset:40960
    v_mfma_f32_16x16x32_bf16 v[64:67], v[244:247], v[32:35], v[64:67]
    ds_read_b128 v[236:239], v4 offset:40960
    v_mfma_f32_16x16x32_bf16 v[68:71], v[240:243], v[20:23], v[68:71]
    v_mfma_f32_16x16x32_bf16 v[68:71], v[244:247], v[36:39], v[68:71]
    buffer_store_dwordx2 v[142:143], v15, s[36:39], s71 offen nt
    v_mfma_f32_16x16x32_bf16 v[72:75], v[240:243], v[24:27], v[72:75]
    v_mfma_f32_16x16x32_bf16 v[72:75], v[244:247], v[40:43], v[72:75]
    v_mfma_f32_16x16x32_bf16 v[76:79], v[240:243], v[28:31], v[76:79]
    v_mfma_f32_16x16x32_bf16 v[76:79], v[244:247], v[44:47], v[76:79]
    s_waitcnt lgkmcnt(4)
    v_mfma_f32_16x16x32_bf16 v[48:51], v[216:219], a[0:3], 0
    ds_read_b128 v[240:243], v3 offset:43008
    v_mfma_f32_16x16x32_bf16 v[48:51], v[220:223], a[16:19], v[48:51]
    ds_read_b128 v[244:247], v4 offset:43008
    v_mfma_f32_16x16x32_bf16 v[52:55], v[216:219], a[4:7], 0
    v_mfma_f32_16x16x32_bf16 v[52:55], v[220:223], a[20:23], v[52:55]
    v_mfma_f32_16x16x32_bf16 v[56:59], v[216:219], a[8:11], 0
    v_cvt_pk_bf16_f32 v144, v64, v68
    v_mfma_f32_16x16x32_bf16 v[56:59], v[220:223], a[24:27], v[56:59]
    v_cvt_pk_bf16_f32 v145, v72, v76
    v_mfma_f32_16x16x32_bf16 v[60:63], v[216:219], a[12:15], 0
    buffer_store_dwordx2 v[144:145], v12, s[36:39], s57 offen sc0 sc1
    v_mfma_f32_16x16x32_bf16 v[60:63], v[220:223], a[28:31], v[60:63]
    v_cvt_pk_bf16_f32 v146, v65, v69
    s_waitcnt lgkmcnt(4)
    v_mfma_f32_16x16x32_bf16 v[48:51], v[224:227], a[32:35], v[48:51]
    ds_read_b128 v[216:219], v3 offset:45056
    v_mfma_f32_16x16x32_bf16 v[48:51], v[228:231], a[48:51], v[48:51]
    ds_read_b128 v[220:223], v4 offset:45056
    v_mfma_f32_16x16x32_bf16 v[52:55], v[224:227], a[36:39], v[52:55]
    v_cvt_pk_bf16_f32 v147, v73, v77
    v_mfma_f32_16x16x32_bf16 v[52:55], v[228:231], a[52:55], v[52:55]
    buffer_store_dwordx2 v[146:147], v13, s[36:39], s57 offen sc0 sc1
    v_mfma_f32_16x16x32_bf16 v[56:59], v[224:227], a[40:43], v[56:59]
    v_cvt_pk_bf16_f32 v148, v66, v70
    v_mfma_f32_16x16x32_bf16 v[56:59], v[228:231], a[56:59], v[56:59]
    v_cvt_pk_bf16_f32 v149, v74, v78
    v_mfma_f32_16x16x32_bf16 v[60:63], v[224:227], a[44:47], v[60:63]
    v_cvt_pk_bf16_f32 v150, v67, v71
    v_mfma_f32_16x16x32_bf16 v[60:63], v[228:231], a[60:63], v[60:63]
    buffer_store_dwordx2 v[148:149], v14, s[36:39], s57 offen sc0 sc1
    s_waitcnt lgkmcnt(4)
    v_mfma_f32_16x16x32_bf16 v[48:51], v[232:235], a[64:67], v[48:51]
    ds_read_b128 v[224:227], v3 offset:47104
    v_mfma_f32_16x16x32_bf16 v[48:51], v[236:239], a[80:83], v[48:51]
    ds_read_b128 v[228:231], v4 offset:47104
    v_mfma_f32_16x16x32_bf16 v[52:55], v[232:235], a[68:71], v[52:55]
    v_cvt_pk_bf16_f32 v151, v75, v79
    v_mfma_f32_16x16x32_bf16 v[52:55], v[236:239], a[84:87], v[52:55]
    buffer_store_dwordx2 v[150:151], v15, s[36:39], s57 offen sc0 sc1
    v_mfma_f32_16x16x32_bf16 v[56:59], v[232:235], a[72:75], v[56:59]
    s_add_u32 s71, s71, 147456
    v_cvt_pk_bf16_f32 v136, v200, v204
    v_mfma_f32_16x16x32_bf16 v[56:59], v[236:239], a[88:91], v[56:59]
    v_cvt_pk_bf16_f32 v137, v208, v212
    v_mfma_f32_16x16x32_bf16 v[60:63], v[232:235], a[76:79], v[60:63]
    v_cvt_pk_bf16_f32 v138, v201, v205
    v_mfma_f32_16x16x32_bf16 v[60:63], v[236:239], a[92:95], v[60:63]
    buffer_store_dwordx2 v[136:137], v12, s[36:39], s71 offen sc0 sc1
    s_waitcnt lgkmcnt(4)
    v_mfma_f32_16x16x32_bf16 v[48:51], v[240:243], a[96:99], v[48:51]
    ds_read_b128 v[232:235], v3 offset:49152
    v_mfma_f32_16x16x32_bf16 v[48:51], v[244:247], a[112:115], v[48:51]
    ds_read_b128 v[236:239], v4 offset:49152
    v_mfma_f32_16x16x32_bf16 v[52:55], v[240:243], a[100:103], v[52:55]
    v_cvt_pk_bf16_f32 v139, v209, v213
    v_mfma_f32_16x16x32_bf16 v[52:55], v[244:247], a[116:119], v[52:55]
    buffer_store_dwordx2 v[138:139], v13, s[36:39], s71 offen sc0 sc1
    v_mfma_f32_16x16x32_bf16 v[56:59], v[240:243], a[104:107], v[56:59]
    v_cvt_pk_bf16_f32 v140, v202, v206
    v_mfma_f32_16x16x32_bf16 v[56:59], v[244:247], a[120:123], v[56:59]
    v_cvt_pk_bf16_f32 v141, v210, v214
    v_mfma_f32_16x16x32_bf16 v[60:63], v[240:243], a[108:111], v[60:63]
    v_cvt_pk_bf16_f32 v142, v203, v207
    v_mfma_f32_16x16x32_bf16 v[60:63], v[244:247], a[124:127], v[60:63]
    buffer_store_dwordx2 v[140:141], v14, s[36:39], s71 offen sc0 sc1
    s_waitcnt lgkmcnt(4)
    v_mfma_f32_16x16x32_bf16 v[48:51], v[216:219], a[128:131], v[48:51]
    ds_read_b128 v[240:243], v3 offset:51200
    v_mfma_f32_16x16x32_bf16 v[48:51], v[220:223], a[144:147], v[48:51]
    ds_read_b128 v[244:247], v4 offset:51200
    v_mfma_f32_16x16x32_bf16 v[52:55], v[216:219], a[132:135], v[52:55]
    v_cvt_pk_bf16_f32 v143, v211, v215
    v_mfma_f32_16x16x32_bf16 v[52:55], v[220:223], a[148:151], v[52:55]
    buffer_store_dwordx2 v[142:143], v15, s[36:39], s71 offen sc0 sc1
    v_mfma_f32_16x16x32_bf16 v[56:59], v[216:219], a[136:139], v[56:59]
    v_mfma_f32_16x16x32_bf16 v[56:59], v[220:223], a[152:155], v[56:59]
    v_mfma_f32_16x16x32_bf16 v[60:63], v[216:219], a[140:143], v[60:63]
    v_mfma_f32_16x16x32_bf16 v[60:63], v[220:223], a[156:159], v[60:63]
    s_waitcnt lgkmcnt(4)
    v_mfma_f32_16x16x32_bf16 v[48:51], v[224:227], a[160:163], v[48:51]
    ds_read_b128 v[216:219], v3 offset:53248
    v_mfma_f32_16x16x32_bf16 v[48:51], v[228:231], a[176:179], v[48:51]
    ds_read_b128 v[220:223], v4 offset:53248
    v_mfma_f32_16x16x32_bf16 v[52:55], v[224:227], a[164:167], v[52:55]
    v_mfma_f32_16x16x32_bf16 v[52:55], v[228:231], a[180:183], v[52:55]
    v_mfma_f32_16x16x32_bf16 v[56:59], v[224:227], a[168:171], v[56:59]
    v_mfma_f32_16x16x32_bf16 v[56:59], v[228:231], a[184:187], v[56:59]
    v_mfma_f32_16x16x32_bf16 v[60:63], v[224:227], a[172:175], v[60:63]
    v_mfma_f32_16x16x32_bf16 v[60:63], v[228:231], a[188:191], v[60:63]
    s_waitcnt lgkmcnt(4)
    v_mfma_f32_16x16x32_bf16 v[48:51], v[232:235], a[192:195], v[48:51]
    v_mfma_f32_16x16x32_bf16 v[48:51], v[236:239], a[208:211], v[48:51]
    v_mfma_f32_16x16x32_bf16 v[52:55], v[232:235], a[196:199], v[52:55]
    v_mfma_f32_16x16x32_bf16 v[52:55], v[236:239], a[212:215], v[52:55]
    v_mfma_f32_16x16x32_bf16 v[56:59], v[232:235], a[200:203], v[56:59]
    v_mfma_f32_16x16x32_bf16 v[56:59], v[236:239], a[216:219], v[56:59]
    v_mfma_f32_16x16x32_bf16 v[60:63], v[232:235], a[204:207], v[60:63]
    v_mfma_f32_16x16x32_bf16 v[60:63], v[236:239], a[220:223], v[60:63]
    s_cmp_eq_u32 s66, 0
    s_cbranch_scc1 L_small_tail
    s_cmp_eq_u32 s68, 1
    s_cbranch_scc1 L_mid1_tail
    s_waitcnt lgkmcnt(2)
    v_mfma_f32_16x16x32_bf16 v[48:51], v[240:243], a[224:227], v[48:51]
    s_waitcnt vmcnt(16) lgkmcnt(0)
    s_barrier
    v_mfma_f32_16x16x32_bf16 v[48:51], v[244:247], a[240:243], v[48:51]
    ds_read_b128 v[224:227], v5 offset:8192
    v_mfma_f32_16x16x32_bf16 v[52:55], v[240:243], a[228:231], v[52:55]
    ds_read_b128 v[228:231], v6 offset:8192
    v_mfma_f32_16x16x32_bf16 v[52:55], v[244:247], a[244:247], v[52:55]
    ds_read_b128 v[232:235], v5 offset:10240
    v_mfma_f32_16x16x32_bf16 v[56:59], v[240:243], a[232:235], v[56:59]
    ds_read_b128 v[236:239], v6 offset:10240
    v_mfma_f32_16x16x32_bf16 v[56:59], v[244:247], a[248:251], v[56:59]
    s_lshl_b32 s57, s8, 3
    v_mfma_f32_16x16x32_bf16 v[60:63], v[240:243], a[236:239], v[60:63]
    v_mfma_f32_16x16x32_bf16 v[60:63], v[244:247], a[252:255], v[60:63]
    v_mfma_f32_16x16x32_bf16 v[48:51], v[216:219], v[16:19], v[48:51]
    ds_read_b128 v[240:243], v5 offset:12288
    v_mfma_f32_16x16x32_bf16 v[48:51], v[220:223], v[32:35], v[48:51]
    ds_read_b128 v[244:247], v6 offset:12288
    v_mfma_f32_16x16x32_bf16 v[52:55], v[216:219], v[20:23], v[52:55]
    v_mfma_f32_16x16x32_bf16 v[52:55], v[220:223], v[36:39], v[52:55]
    v_mfma_f32_16x16x32_bf16 v[56:59], v[216:219], v[24:27], v[56:59]
    v_mfma_f32_16x16x32_bf16 v[56:59], v[220:223], v[40:43], v[56:59]
    v_mfma_f32_16x16x32_bf16 v[60:63], v[216:219], v[28:31], v[60:63]
    v_mfma_f32_16x16x32_bf16 v[60:63], v[220:223], v[44:47], v[60:63]
    s_waitcnt lgkmcnt(4)
    v_mfma_f32_16x16x32_bf16 v[64:67], v[224:227], a[0:3], 0
    ds_read_b128 v[216:219], v5 offset:14336
    v_mfma_f32_16x16x32_bf16 v[64:67], v[228:231], a[16:19], v[64:67]
    ds_read_b128 v[220:223], v6 offset:14336
    v_mfma_f32_16x16x32_bf16 v[68:71], v[224:227], a[4:7], 0
    v_mfma_f32_16x16x32_bf16 v[68:71], v[228:231], a[20:23], v[68:71]
    s_waitcnt lgkmcnt(4)
    v_mfma_f32_16x16x32_bf16 v[64:67], v[232:235], a[32:35], v[64:67]
    ds_read_b128 v[224:227], v5 offset:16384
    v_mfma_f32_16x16x32_bf16 v[64:67], v[236:239], a[48:51], v[64:67]
    ds_read_b128 v[228:231], v6 offset:16384
    v_mfma_f32_16x16x32_bf16 v[68:71], v[232:235], a[36:39], v[68:71]
    v_cvt_pk_bf16_f32 v144, v48, v52
    v_mfma_f32_16x16x32_bf16 v[68:71], v[236:239], a[52:55], v[68:71]
    v_cvt_pk_bf16_f32 v145, v56, v60
    s_waitcnt lgkmcnt(4)
    v_mfma_f32_16x16x32_bf16 v[64:67], v[240:243], a[64:67], v[64:67]
    buffer_store_dwordx2 v[144:145], v12, s[36:39], s57 offen sc0 sc1
    v_mfma_f32_16x16x32_bf16 v[64:67], v[244:247], a[80:83], v[64:67]
    ds_read_b128 v[232:235], v5 offset:18432
    v_mfma_f32_16x16x32_bf16 v[68:71], v[240:243], a[68:71], v[68:71]
    ds_read_b128 v[236:239], v6 offset:18432
    v_mfma_f32_16x16x32_bf16 v[68:71], v[244:247], a[84:87], v[68:71]
    v_cvt_pk_bf16_f32 v146, v49, v53
    s_waitcnt lgkmcnt(4)
    v_mfma_f32_16x16x32_bf16 v[64:67], v[216:219], a[96:99], v[64:67]
    ds_read_b128 v[240:243], v5 offset:20480
    v_mfma_f32_16x16x32_bf16 v[64:67], v[220:223], a[112:115], v[64:67]
    ds_read_b128 v[244:247], v6 offset:20480
    v_mfma_f32_16x16x32_bf16 v[68:71], v[216:219], a[100:103], v[68:71]
    v_cvt_pk_bf16_f32 v147, v57, v61
    v_mfma_f32_16x16x32_bf16 v[68:71], v[220:223], a[116:119], v[68:71]
    buffer_store_dwordx2 v[146:147], v13, s[36:39], s57 offen sc0 sc1
    s_waitcnt lgkmcnt(4)
    v_mfma_f32_16x16x32_bf16 v[64:67], v[224:227], a[128:131], v[64:67]
    ds_read_b128 v[216:219], v5 offset:22528
    v_mfma_f32_16x16x32_bf16 v[64:67], v[228:231], a[144:147], v[64:67]
    ds_read_b128 v[220:223], v6 offset:22528
    v_mfma_f32_16x16x32_bf16 v[68:71], v[224:227], a[132:135], v[68:71]
    v_cvt_pk_bf16_f32 v148, v50, v54
    v_mfma_f32_16x16x32_bf16 v[68:71], v[228:231], a[148:151], v[68:71]
    v_cvt_pk_bf16_f32 v149, v58, v62
    s_waitcnt lgkmcnt(4)
    v_mfma_f32_16x16x32_bf16 v[64:67], v[232:235], a[160:163], v[64:67]
    buffer_store_dwordx2 v[148:149], v14, s[36:39], s57 offen sc0 sc1
    v_mfma_f32_16x16x32_bf16 v[64:67], v[236:239], a[176:179], v[64:67]
    ds_read_b128 v[224:227], v5 offset:24576
    v_mfma_f32_16x16x32_bf16 v[68:71], v[232:235], a[164:167], v[68:71]
    ds_read_b128 v[228:231], v6 offset:24576
    v_mfma_f32_16x16x32_bf16 v[68:71], v[236:239], a[180:183], v[68:71]
    v_cvt_pk_bf16_f32 v150, v51, v55
    s_waitcnt lgkmcnt(4)
    v_mfma_f32_16x16x32_bf16 v[64:67], v[240:243], a[192:195], v[64:67]
    v_cvt_pk_bf16_f32 v151, v59, v63
    v_mfma_f32_16x16x32_bf16 v[64:67], v[244:247], a[208:211], v[64:67]
    buffer_store_dwordx2 v[150:151], v15, s[36:39], s57 offen sc0 sc1
    v_mfma_f32_16x16x32_bf16 v[68:71], v[240:243], a[196:199], v[68:71]
    s_lshl_b32 s57, s9, 3
    v_mfma_f32_16x16x32_bf16 v[68:71], v[244:247], a[212:215], v[68:71]
    s_waitcnt lgkmcnt(2)
    v_mfma_f32_16x16x32_bf16 v[64:67], v[216:219], a[224:227], v[64:67]
    v_mfma_f32_16x16x32_bf16 v[64:67], v[220:223], a[240:243], v[64:67]
    v_mfma_f32_16x16x32_bf16 v[68:71], v[216:219], a[228:231], v[68:71]
    v_mfma_f32_16x16x32_bf16 v[68:71], v[220:223], a[244:247], v[68:71]
    s_waitcnt lgkmcnt(0)
    v_mfma_f32_16x16x32_bf16 v[64:67], v[224:227], v[16:19], v[64:67]
    v_mfma_f32_16x16x32_bf16 v[64:67], v[228:231], v[32:35], v[64:67]
    v_mfma_f32_16x16x32_bf16 v[68:71], v[224:227], v[20:23], v[68:71]
    v_mfma_f32_16x16x32_bf16 v[68:71], v[228:231], v[36:39], v[68:71]
    s_nop 7
    v_cvt_pk_bf16_f32 v136, v64, v68
    buffer_store_dword v136, v12, s[36:39], s57 offen offset:0 nt
    v_cvt_pk_bf16_f32 v137, v65, v69
    buffer_store_dword v137, v13, s[36:39], s57 offen offset:0 nt
    v_cvt_pk_bf16_f32 v138, v66, v70
    buffer_store_dword v138, v14, s[36:39], s57 offen offset:0 nt
    v_cvt_pk_bf16_f32 v139, v67, v71
    buffer_store_dword v139, v15, s[36:39], s57 offen offset:0 nt
    s_endpgm
    .p2align 12
L_pad_mid1:
    s_setpc_b64 s[78:79]
L_mid1_tail:
    s_waitcnt lgkmcnt(2)
    v_mfma_f32_16x16x32_bf16 v[48:51], v[240:243], a[224:227], v[48:51]
    s_waitcnt vmcnt(16) lgkmcnt(0)
    s_barrier
    v_mfma_f32_16x16x32_bf16 v[48:51], v[244:247], a[240:243], v[48:51]
    ds_read_b128 v[224:227], v5 offset:8192
    v_mfma_f32_16x16x32_bf16 v[52:55], v[240:243], a[228:231], v[52:55]
    ds_read_b128 v[228:231], v6 offset:8192
    v_mfma_f32_16x16x32_bf16 v[52:55], v[244:247], a[244:247], v[52:55]
    ds_read_b128 v[232:235], v5 offset:10240
    v_mfma_f32_16x16x32_bf16 v[56:59], v[240:243], a[232:235], v[56:59]
    ds_read_b128 v[236:239], v6 offset:10240
    v_mfma_f32_16x16x32_bf16 v[56:59], v[244:247], a[248:251], v[56:59]
    s_lshl_b32 s57, s8, 3
    v_mfma_f32_16x16x32_bf16 v[60:63], v[240:243], a[236:239], v[60:63]
    v_mfma_f32_16x16x32_bf16 v[60:63], v[244:247], a[252:255], v[60:63]
    v_mfma_f32_16x16x32_bf16 v[48:51], v[216:219], v[16:19], v[48:51]
    ds_read_b128 v[240:243], v5 offset:12288
    v_mfma_f32_16x16x32_bf16 v[48:51], v[220:223], v[32:35], v[48:51]
    ds_read_b128 v[244:247], v6 offset:12288
    v_mfma_f32_16x16x32_bf16 v[52:55], v[216:219], v[20:23], v[52:55]
    v_mfma_f32_16x16x32_bf16 v[52:55], v[220:223], v[36:39], v[52:55]
    v_mfma_f32_16x16x32_bf16 v[56:59], v[216:219], v[24:27], v[56:59]
    v_mfma_f32_16x16x32_bf16 v[56:59], v[220:223], v[40:43], v[56:59]
    v_mfma_f32_16x16x32_bf16 v[60:63], v[216:219], v[28:31], v[60:63]
    v_mfma_f32_16x16x32_bf16 v[60:63], v[220:223], v[44:47], v[60:63]
    s_waitcnt lgkmcnt(4)
    v_mfma_f32_16x16x32_bf16 v[64:67], v[224:227], a[8:11], 0
    ds_read_b128 v[216:219], v5 offset:14336
    v_mfma_f32_16x16x32_bf16 v[64:67], v[228:231], a[24:27], v[64:67]
    ds_read_b128 v[220:223], v6 offset:14336
    v_mfma_f32_16x16x32_bf16 v[68:71], v[224:227], a[12:15], 0
    v_mfma_f32_16x16x32_bf16 v[68:71], v[228:231], a[28:31], v[68:71]
    s_waitcnt lgkmcnt(4)
    v_mfma_f32_16x16x32_bf16 v[64:67], v[232:235], a[40:43], v[64:67]
    ds_read_b128 v[224:227], v5 offset:16384
    v_mfma_f32_16x16x32_bf16 v[64:67], v[236:239], a[56:59], v[64:67]
    ds_read_b128 v[228:231], v6 offset:16384
    v_mfma_f32_16x16x32_bf16 v[68:71], v[232:235], a[44:47], v[68:71]
    v_cvt_pk_bf16_f32 v144, v48, v52
    v_mfma_f32_16x16x32_bf16 v[68:71], v[236:239], a[60:63], v[68:71]
    v_cvt_pk_bf16_f32 v145, v56, v60
    s_waitcnt lgkmcnt(4)
    v_mfma_f32_16x16x32_bf16 v[64:67], v[240:243], a[72:75], v[64:67]
    buffer_store_dwordx2 v[144:145], v12, s[36:39], s57 offen sc0 sc1
    v_mfma_f32_16x16x32_bf16 v[64:67], v[244:247], a[88:91], v[64:67]
    ds_read_b128 v[232:235], v5 offset:18432
    v_mfma_f32_16x16x32_bf16 v[68:71], v[240:243], a[76:79], v[68:71]
    ds_read_b128 v[236:239], v6 offset:18432
    v_mfma_f32_16x16x32_bf16 v[68:71], v[244:247], a[92:95], v[68:71]
    v_cvt_pk_bf16_f32 v146, v49, v53
    s_waitcnt lgkmcnt(4)
    v_mfma_f32_16x16x32_bf16 v[64:67], v[216:219], a[104:107], v[64:67]
    ds_read_b128 v[240:243], v5 offset:20480
    v_mfma_f32_16x16x32_bf16 v[64:67], v[220:223], a[120:123], v[64:67]
    ds_read_b128 v[244:247], v6 offset:20480
    v_mfma_f32_16x16x32_bf16 v[68:71], v[216:219], a[108:111], v[68:71]
    v_cvt_pk_bf16_f32 v147, v57, v61
    v_mfma_f32_16x16x32_bf16 v[68:71], v[220:223], a[124:127], v[68:71]
    buffer_store_dwordx2 v[146:147], v13, s[36:39], s57 offen sc0 sc1
    s_waitcnt lgkmcnt(4)
    v_mfma_f32_16x16x32_bf16 v[64:67], v[224:227], a[136:139], v[64:67]
    ds_read_b128 v[216:219], v5 offset:22528
    v_mfma_f32_16x16x32_bf16 v[64:67], v[228:231], a[152:155], v[64:67]
    ds_read_b128 v[220:223], v6 offset:22528
    v_mfma_f32_16x16x32_bf16 v[68:71], v[224:227], a[140:143], v[68:71]
    v_cvt_pk_bf16_f32 v148, v50, v54
    v_mfma_f32_16x16x32_bf16 v[68:71], v[228:231], a[156:159], v[68:71]
    v_cvt_pk_bf16_f32 v149, v58, v62
    s_waitcnt lgkmcnt(4)
    v_mfma_f32_16x16x32_bf16 v[64:67], v[232:235], a[168:171], v[64:67]
    buffer_store_dwordx2 v[148:149], v14, s[36:39], s57 offen sc0 sc1
    v_mfma_f32_16x16x32_bf16 v[64:67], v[236:239], a[184:187], v[64:67]
    ds_read_b128 v[224:227], v5 offset:24576
    v_mfma_f32_16x16x32_bf16 v[68:71], v[232:235], a[172:175], v[68:71]
    ds_read_b128 v[228:231], v6 offset:24576
    v_mfma_f32_16x16x32_bf16 v[68:71], v[236:239], a[188:191], v[68:71]
    v_cvt_pk_bf16_f32 v150, v51, v55
    s_waitcnt lgkmcnt(4)
    v_mfma_f32_16x16x32_bf16 v[64:67], v[240:243], a[200:203], v[64:67]
    v_cvt_pk_bf16_f32 v151, v59, v63
    v_mfma_f32_16x16x32_bf16 v[64:67], v[244:247], a[216:219], v[64:67]
    buffer_store_dwordx2 v[150:151], v15, s[36:39], s57 offen sc0 sc1
    v_mfma_f32_16x16x32_bf16 v[68:71], v[240:243], a[204:207], v[68:71]
    s_lshl_b32 s57, s9, 3
    v_mfma_f32_16x16x32_bf16 v[68:71], v[244:247], a[220:223], v[68:71]
    s_waitcnt lgkmcnt(2)
    v_mfma_f32_16x16x32_bf16 v[64:67], v[216:219], a[232:235], v[64:67]
    v_mfma_f32_16x16x32_bf16 v[64:67], v[220:223], a[248:251], v[64:67]
    v_mfma_f32_16x16x32_bf16 v[68:71], v[216:219], a[236:239], v[68:71]
    v_mfma_f32_16x16x32_bf16 v[68:71], v[220:223], a[252:255], v[68:71]
    s_waitcnt lgkmcnt(0)
    v_mfma_f32_16x16x32_bf16 v[64:67], v[224:227], v[24:27], v[64:67]
    v_mfma_f32_16x16x32_bf16 v[64:67], v[228:231], v[40:43], v[64:67]
    v_mfma_f32_16x16x32_bf16 v[68:71], v[224:227], v[28:31], v[68:71]
    v_mfma_f32_16x16x32_bf16 v[68:71], v[228:231], v[44:47], v[68:71]
    s_nop 7
    v_cvt_pk_bf16_f32 v136, v64, v68
    buffer_store_dword v136, v12, s[36:39], s57 offen offset:4 nt
    v_cvt_pk_bf16_f32 v137, v65, v69
    buffer_store_dword v137, v13, s[36:39], s57 offen offset:4 nt
    v_cvt_pk_bf16_f32 v138, v66, v70
    buffer_store_dword v138, v14, s[36:39], s57 offen offset:4 nt
    v_cvt_pk_bf16_f32 v139, v67, v71
    buffer_store_dword v139, v15, s[36:39], s57 offen offset:4 nt
    s_endpgm
    .p2align 6
L_pad_small:
    s_setpc_b64 s[78:79]
L_small_tail:
    s_waitcnt lgkmcnt(2)
    v_mfma_f32_16x16x32_bf16 v[48:51], v[240:243], a[224:227], v[48:51]
    s_lshl_b32 s57, s8, 3
    v_mfma_f32_16x16x32_bf16 v[48:51], v[244:247], a[240:243], v[48:51]
    v_mfma_f32_16x16x32_bf16 v[52:55], v[240:243], a[228:231], v[52:55]
    v_mfma_f32_16x16x32_bf16 v[52:55], v[244:247], a[244:247], v[52:55]
    v_mfma_f32_16x16x32_bf16 v[56:59], v[240:243], a[232:235], v[56:59]
    v_mfma_f32_16x16x32_bf16 v[56:59], v[244:247], a[248:251], v[56:59]
    v_mfma_f32_16x16x32_bf16 v[60:63], v[240:243], a[236:239], v[60:63]
    v_mfma_f32_16x16x32_bf16 v[60:63], v[244:247], a[252:255], v[60:63]
    s_waitcnt lgkmcnt(0)
    v_mfma_f32_16x16x32_bf16 v[48:51], v[216:219], v[16:19], v[48:51]
    v_mfma_f32_16x16x32_bf16 v[48:51], v[220:223], v[32:35], v[48:51]
    v_mfma_f32_16x16x32_bf16 v[52:55], v[216:219], v[20:23], v[52:55]
    v_mfma_f32_16x16x32_bf16 v[52:55], v[220:223], v[36:39], v[52:55]
    v_mfma_f32_16x16x32_bf16 v[56:59], v[216:219], v[24:27], v[56:59]
    v_mfma_f32_16x16x32_bf16 v[56:59], v[220:223], v[40:43], v[56:59]
    v_mfma_f32_16x16x32_bf16 v[60:63], v[216:219], v[28:31], v[60:63]
    v_mfma_f32_16x16x32_bf16 v[60:63], v[220:223], v[44:47], v[60:63]
    s_nop 7
    v_cvt_pk_bf16_f32 v144, v48, v52
    v_cvt_pk_bf16_f32 v145, v56, v60
    buffer_store_dwordx2 v[144:145], v12, s[36:39], s57 offen sc0 sc1
    v_cvt_pk_bf16_f32 v146, v49, v53
    v_cvt_pk_bf16_f32 v147, v57, v61
    buffer_store_dwordx2 v[146:147], v13, s[36:39], s57 offen sc0 sc1
    v_cvt_pk_bf16_f32 v148, v50, v54
    v_cvt_pk_bf16_f32 v149, v58, v62
    buffer_store_dwordx2 v[148:149], v14, s[36:39], s57 offen sc0 sc1
    v_cvt_pk_bf16_f32 v150, v51, v55
    v_cvt_pk_bf16_f32 v151, v59, v63
    buffer_store_dwordx2 v[150:151], v15, s[36:39], s57 offen sc0 sc1
L_fin:
L_done:
s_endpgm
.section .rodata,"a"
.p2align 6
.amdhsa_kernel standalone__weight_only_int_omniquant__prompt_kernel
  .amdhsa_next_free_vgpr 512
  .amdhsa_next_free_sgpr 102
  .amdhsa_accum_offset 256
  .amdhsa_group_segment_fixed_size 0
  .amdhsa_kernarg_size 64
  .amdhsa_user_sgpr_count 2
  .amdhsa_user_sgpr_kernarg_segment_ptr 1
  .amdhsa_system_sgpr_workgroup_id_x 1
  .amdhsa_float_denorm_mode_32 3
.end_amdhsa_kernel
```
